```python
import torch

def _softmax(x, axis=-1):
    return torch.softmax(x, dim=axis)
def _gelu(x):
    return torch.nn.functional.gelu(x, approximate="tanh")
def _silu(x):
    return torch.nn.functional.silu(x)
def _sigmoid(x):
    return torch.sigmoid(x)
def _layernorm(x, axis=-1, eps=1e-5):
    m = x.mean(dim=axis, keepdim=True)
    v = x.var(dim=axis, keepdim=True, unbiased=False)
    return (x - m) / torch.sqrt(v + eps)
def _scatter_add(tgt, idx, src, axis=0):
    return tgt.clone().index_add_(axis, idx, src)
def _segment_sum(src, seg, n):
    out = torch.zeros((n,) + src.shape[1:], dtype=src.dtype)
    return out.index_add_(0, seg, src)
def _pad(x, pw):
    flat = tuple(v for pair in reversed(pw) for v in pair)
    return torch.nn.functional.pad(x, flat)

kernel_name = 'concat_heads__softmax_full_mha__sliding_local_dilated__prompt'

def setup_inputs():

    _w = (lambda a: (lambda t: t.to(torch.bfloat16) if t.is_floating_point() else t)(torch.as_tensor(a)))
    def _A_setup():
        B, S, D = 1, 2048, 448
        return {
            "x": _w((lambda *s: torch.randn(*s, dtype=torch.bfloat16) * 0.2)(B, S, D)),
            "wqkv": _w((lambda *s: torch.randn(*s, dtype=torch.bfloat16) * 0.8)(D, 3 * D)),
            "wo": _w((lambda *s: torch.randn(*s, dtype=torch.bfloat16) * 0.2)(D, D)),
        }
    _A_in = _A_setup()

    def _B_setup():
        B, S, D = 1, 2048, 448
        return {
            "x": _w((lambda *s: torch.randn(*s, dtype=torch.bfloat16) * 0.4)(B, S, D)),
            "wqkv": _w((lambda *s: torch.randn(*s, dtype=torch.bfloat16) * 0.8)(D, 3 * D)),
            "wo": _w((lambda *s: torch.randn(*s, dtype=torch.bfloat16) * 0.1)(D, D)),
        }
    _B_in = _B_setup()

    return {
        "A_x": _A_in["x"],
        "A_wqkv": _A_in["wqkv"],
        "A_wo": _A_in["wo"],
        "B_x": _B_in["x"],
        "B_wqkv": _B_in["wqkv"],
        "B_wo": _B_in["wo"],
    }

def reference(A_x, A_wqkv, A_wo, B_x, B_wqkv, B_wo):
    def _A_ref(x, wqkv, wo):
        B, S, D = x.shape
        H = 16; Dh = D // H
        qkv = (lambda x, *d: x.permute(*d))((x @ wqkv).reshape(B, S, 3, H, Dh), 2, 0, 3, 1, 4)
        q, k, v = qkv[0], qkv[1], qkv[2]
        scale = Dh ** -0.5
        scores = torch.einsum("bhqd,bhkd->bhqk", q, k) * scale
        p = _softmax(scores, axis=-1)
        o = torch.einsum("bhqk,bhkd->bhqd", p, v)
        return (lambda x, *d: x.permute(*d))(o, 0, 2, 1, 3).reshape(B, S, D) @ wo

    def _B_ref(x, wqkv, wo):
        B, S, D = x.shape
        H = 16; Dh = D // H
        W, dil = 8, 2
        qkv = (lambda x, *d: x.permute(*d))((x @ wqkv).reshape(B, S, 3, H, Dh), 2, 0, 3, 1, 4)
        q, k, v = qkv[0], qkv[1], qkv[2]
        scale = Dh ** -0.5
        pos = torch.arange(S)
        off = torch.arange(W) * dil
        idx = pos[:, None] - off[None, :]
        mask = idx >= 0
        idx_c = torch.where(mask, idx, 0).reshape(-1)
        kg = k[:, :, idx_c, :].reshape(B, H, S, W, Dh)
        vg = v[:, :, idx_c, :].reshape(B, H, S, W, Dh)
        logits = torch.einsum("bhsd,bhswd->bhsw", q, kg) * scale
        logits = torch.where(mask[None, None, :, :], logits, -1e9)
        attn = _softmax(logits, axis=-1)
        o = torch.einsum("bhsw,bhswd->bhsd", attn, vg)
        return (lambda x, *d: x.permute(*d))(o, 0, 2, 1, 3).reshape(B, S, D) @ wo

    a = _A_ref(A_x, A_wqkv, A_wo)
    b = _B_ref(B_x, B_wqkv, B_wo)
    return torch.concatenate([a, b], axis=-1)
```

```asm
; @launch kernel=qkv_kernel grid=(256,1,1) block=(512,1,1) lds=163840
; @launch kernel=attn_kernel grid=(256,1,1) block=(768,1,1) lds=163840
.amdgcn_target "amdgcn-amd-amdhsa--gfx950"
.text
.globl qkv_kernel
.p2align 8
.type qkv_kernel,@function
qkv_kernel:
    s_cmp_ge_u32 s2, 256
    s_cbranch_scc1 L_k1_end
    s_load_dwordx4 s[4:7], s[0:1], 0
    s_load_dwordx4 s[8:11], s[0:1], 24
    s_load_dwordx2 s[12:13], s[0:1], 64
    v_lshrrev_b32 v1, 6, v0
    v_and_b32 v0, 63, v0
    s_and_b32 s32, s2, 7
    s_lshr_b32 s33, s2, 3
    v_readfirstlane_b32 s28, v1
    s_cmp_ge_u32 s33, 28
    s_cbranch_scc1 L_k1_pads
    s_lshr_b32 s29, s32, 2
    s_and_b32 s31, s32, 3
    s_lshl_b32 s31, s31, 2
    s_and_b32 s34, s33, 3
    s_add_u32 s31, s31, s34
    s_lshr_b32 s30, s33, 2
    s_cmp_lt_u32 s28, 4
    s_cbranch_scc1 L_k1_comp
    s_sub_u32 s28, s28, 4
    s_lshl_b32 s35, s31, 7
    s_lshl_b32 s36, s28, 5
    s_add_u32 s35, s35, s36
    v_lshrrev_b32 v7, 3, v0
    v_add_u32 v4, s35, v7
    v_mul_u32_u24 v4, 896, v4
    v_and_b32 v5, 7, v0
    v_lshrrev_b32 v6, 4, v0
    v_xor_b32 v8, v5, v6
    v_lshl_add_u32 v2, v8, 4, v4
    v_xor_b32 v8, 4, v8
    v_lshl_add_u32 v3, v8, 4, v4
    v_add_u32 v3, 7168, v3
    v_add_u32 v9, 14336, v2
    v_add_u32 v10, 14336, v3
    s_lshl_b32 s36, s28, 4
    v_add_u32 v7, s36, v7
    v_mul_u32_u24 v7, 2688, v7
    v_and_b32 v6, 1, v6
    v_lshlrev_b32 v6, 2, v6
    v_xor_b32 v5, v5, v6
    v_lshl_add_u32 v4, v5, 4, v7
    s_lshl_b32 s37, s30, 7
    v_add_u32 v4, s37, v4
    v_add_u32 v5, 21504, v4
    s_lshl_b32 s48, s28, 12
    s_lshl_b32 s49, s28, 11
    s_add_u32 s37, s31, s30
    s_mul_i32 s39, s37, 9363
    s_lshr_b32 s39, s39, 16
    s_mul_i32 s39, s39, 7
    s_sub_u32 s38, s37, s39
    s_add_u32 s39, s38, 0
    s_lshl_b32 s60, s39, 7
    s_mul_i32 s50, s39, 172032
    s_add_u32 s38, s38, 1
    s_cmp_eq_u32 s38, 7
    s_cselect_b32 s38, 0, s38
    s_add_u32 s39, s38, 0
    s_lshl_b32 s61, s39, 7
    s_mul_i32 s51, s39, 172032
    s_add_u32 s38, s38, 1
    s_cmp_eq_u32 s38, 7
    s_cselect_b32 s38, 0, s38
    s_waitcnt lgkmcnt(0)
    s_cmp_eq_u32 s29, 0
    s_cselect_b32 s14, s4, s8
    s_cselect_b32 s15, s5, s9
    s_cselect_b32 s40, s6, s10
    s_cselect_b32 s41, s7, s11
    s_mov_b32 s16, s14
    s_mov_b32 s17, s15
    s_mov_b32 s18, 1835008
    s_mov_b32 s19, 0x00020000
    s_mov_b32 s20, s40
    s_mov_b32 s21, s41
    s_mov_b32 s22, 1204224
    s_mov_b32 s23, 0x00020000
    s_add_u32 m0, s48, 0
    s_nop 0
    buffer_load_dwordx4 v2, s[16:19], s60 offen lds
    s_add_u32 m0, s48, 1024
    s_nop 0
    buffer_load_dwordx4 v3, s[16:19], s60 offen lds
    s_add_u32 m0, s48, 2048
    s_nop 0
    buffer_load_dwordx4 v9, s[16:19], s60 offen lds
    s_add_u32 m0, s48, 3072
    s_nop 0
    buffer_load_dwordx4 v10, s[16:19], s60 offen lds
    s_add_u32 m0, s49, 16384
    s_nop 0
    buffer_load_dwordx4 v4, s[20:23], s50 offen offset:0 lds
    s_add_u32 m0, s49, 17408
    s_nop 0
    buffer_load_dwordx4 v5, s[20:23], s50 offen offset:0 lds
    s_add_u32 m0, s49, 23680
    s_nop 0
    buffer_load_dwordx4 v4, s[20:23], s50 offen offset:896 lds
    s_add_u32 m0, s49, 24704
    s_nop 0
    buffer_load_dwordx4 v5, s[20:23], s50 offen offset:896 lds
    s_add_u32 m0, s48, 32768
    s_nop 0
    buffer_load_dwordx4 v2, s[16:19], s61 offen lds
    s_add_u32 m0, s48, 33792
    s_nop 0
    buffer_load_dwordx4 v3, s[16:19], s61 offen lds
    s_add_u32 m0, s48, 34816
    s_nop 0
    buffer_load_dwordx4 v9, s[16:19], s61 offen lds
    s_add_u32 m0, s48, 35840
    s_nop 0
    buffer_load_dwordx4 v10, s[16:19], s61 offen lds
    s_add_u32 m0, s49, 49152
    s_nop 0
    buffer_load_dwordx4 v4, s[20:23], s51 offen offset:0 lds
    s_add_u32 m0, s49, 50176
    s_nop 0
    buffer_load_dwordx4 v5, s[20:23], s51 offen offset:0 lds
    s_add_u32 m0, s49, 56448
    s_nop 0
    buffer_load_dwordx4 v4, s[20:23], s51 offen offset:896 lds
    s_add_u32 m0, s49, 57472
    s_nop 0
    buffer_load_dwordx4 v5, s[20:23], s51 offen offset:896 lds
    s_add_u32 s39, s38, 0
    s_lshl_b32 s62, s39, 7
    s_mul_i32 s52, s39, 172032
    s_add_u32 s38, s38, 1
    s_cmp_eq_u32 s38, 7
    s_cselect_b32 s38, 0, s38
    s_add_u32 s39, s38, 0
    s_lshl_b32 s63, s39, 7
    s_mul_i32 s53, s39, 172032
    s_add_u32 s38, s38, 1
    s_cmp_eq_u32 s38, 7
    s_cselect_b32 s38, 0, s38
    s_add_u32 s39, s38, 0
    s_lshl_b32 s64, s39, 7
    s_mul_i32 s54, s39, 172032
    s_add_u32 s38, s38, 1
    s_cmp_eq_u32 s38, 7
    s_cselect_b32 s38, 0, s38
    s_add_u32 s39, s38, 0
    s_lshl_b32 s65, s39, 7
    s_mul_i32 s55, s39, 172032
    s_add_u32 s38, s38, 1
    s_cmp_eq_u32 s38, 7
    s_cselect_b32 s38, 0, s38
    s_add_u32 s39, s38, 0
    s_lshl_b32 s66, s39, 7
    s_mul_i32 s56, s39, 172032
    s_add_u32 s38, s38, 1
    s_cmp_eq_u32 s38, 7
    s_cselect_b32 s38, 0, s38
    s_waitcnt vmcnt(8)
    s_barrier
    s_add_u32 m0, s48, 65536
    s_nop 0
    buffer_load_dwordx4 v2, s[16:19], s62 offen lds
    s_add_u32 m0, s48, 66560
    s_nop 0
    buffer_load_dwordx4 v3, s[16:19], s62 offen lds
    s_add_u32 m0, s48, 67584
    s_nop 0
    buffer_load_dwordx4 v9, s[16:19], s62 offen lds
    s_add_u32 m0, s48, 68608
    s_nop 0
    buffer_load_dwordx4 v10, s[16:19], s62 offen lds
    s_add_u32 m0, s49, 81920
    s_nop 0
    buffer_load_dwordx4 v4, s[20:23], s52 offen offset:0 lds
    s_add_u32 m0, s49, 82944
    s_nop 0
    buffer_load_dwordx4 v5, s[20:23], s52 offen offset:0 lds
    s_add_u32 m0, s49, 89216
    s_nop 0
    buffer_load_dwordx4 v4, s[20:23], s52 offen offset:896 lds
    s_add_u32 m0, s49, 90240
    s_nop 0
    buffer_load_dwordx4 v5, s[20:23], s52 offen offset:896 lds
    s_add_u32 m0, s48, 98304
    s_nop 0
    buffer_load_dwordx4 v2, s[16:19], s63 offen lds
    s_add_u32 m0, s48, 99328
    s_nop 0
    buffer_load_dwordx4 v3, s[16:19], s63 offen lds
    s_add_u32 m0, s48, 100352
    s_nop 0
    buffer_load_dwordx4 v9, s[16:19], s63 offen lds
    s_add_u32 m0, s48, 101376
    s_nop 0
    buffer_load_dwordx4 v10, s[16:19], s63 offen lds
    s_add_u32 m0, s49, 114688
    s_nop 0
    buffer_load_dwordx4 v4, s[20:23], s53 offen offset:0 lds
    s_add_u32 m0, s49, 115712
    s_nop 0
    buffer_load_dwordx4 v5, s[20:23], s53 offen offset:0 lds
    s_add_u32 m0, s49, 121984
    s_nop 0
    buffer_load_dwordx4 v4, s[20:23], s53 offen offset:896 lds
    s_add_u32 m0, s49, 123008
    s_nop 0
    buffer_load_dwordx4 v5, s[20:23], s53 offen offset:896 lds
    s_waitcnt vmcnt(16)
    s_barrier
    s_add_u32 m0, s48, 131072
    s_nop 0
    buffer_load_dwordx4 v2, s[16:19], s64 offen lds
    s_add_u32 m0, s48, 132096
    s_nop 0
    buffer_load_dwordx4 v3, s[16:19], s64 offen lds
    s_add_u32 m0, s48, 133120
    s_nop 0
    buffer_load_dwordx4 v9, s[16:19], s64 offen lds
    s_add_u32 m0, s48, 134144
    s_nop 0
    buffer_load_dwordx4 v10, s[16:19], s64 offen lds
    s_add_u32 m0, s49, 147456
    s_nop 0
    buffer_load_dwordx4 v4, s[20:23], s54 offen offset:0 lds
    s_add_u32 m0, s49, 148480
    s_nop 0
    buffer_load_dwordx4 v5, s[20:23], s54 offen offset:0 lds
    s_add_u32 m0, s49, 154752
    s_nop 0
    buffer_load_dwordx4 v4, s[20:23], s54 offen offset:896 lds
    s_add_u32 m0, s49, 155776
    s_nop 0
    buffer_load_dwordx4 v5, s[20:23], s54 offen offset:896 lds
    s_waitcnt vmcnt(16)
    s_barrier
    s_add_u32 m0, s48, 0
    s_nop 0
    buffer_load_dwordx4 v2, s[16:19], s65 offen lds
    s_add_u32 m0, s48, 1024
    s_nop 0
    buffer_load_dwordx4 v3, s[16:19], s65 offen lds
    s_add_u32 m0, s48, 2048
    s_nop 0
    buffer_load_dwordx4 v9, s[16:19], s65 offen lds
    s_add_u32 m0, s48, 3072
    s_nop 0
    buffer_load_dwordx4 v10, s[16:19], s65 offen lds
    s_add_u32 m0, s49, 16384
    s_nop 0
    buffer_load_dwordx4 v4, s[20:23], s55 offen offset:0 lds
    s_add_u32 m0, s49, 17408
    s_nop 0
    buffer_load_dwordx4 v5, s[20:23], s55 offen offset:0 lds
    s_add_u32 m0, s49, 23680
    s_nop 0
    buffer_load_dwordx4 v4, s[20:23], s55 offen offset:896 lds
    s_add_u32 m0, s49, 24704
    s_nop 0
    buffer_load_dwordx4 v5, s[20:23], s55 offen offset:896 lds
    s_waitcnt vmcnt(16)
    s_barrier
    s_add_u32 m0, s48, 32768
    s_nop 0
    buffer_load_dwordx4 v2, s[16:19], s66 offen lds
    s_add_u32 m0, s48, 33792
    s_nop 0
    buffer_load_dwordx4 v3, s[16:19], s66 offen lds
    s_add_u32 m0, s48, 34816
    s_nop 0
    buffer_load_dwordx4 v9, s[16:19], s66 offen lds
    s_add_u32 m0, s48, 35840
    s_nop 0
    buffer_load_dwordx4 v10, s[16:19], s66 offen lds
    s_add_u32 m0, s49, 49152
    s_nop 0
    buffer_load_dwordx4 v4, s[20:23], s56 offen offset:0 lds
    s_add_u32 m0, s49, 50176
    s_nop 0
    buffer_load_dwordx4 v5, s[20:23], s56 offen offset:0 lds
    s_add_u32 m0, s49, 56448
    s_nop 0
    buffer_load_dwordx4 v4, s[20:23], s56 offen offset:896 lds
    s_add_u32 m0, s49, 57472
    s_nop 0
    buffer_load_dwordx4 v5, s[20:23], s56 offen offset:896 lds
    s_waitcnt vmcnt(16)
    s_barrier
    s_add_u32 m0, s49, 63744
    s_nop 0
    buffer_load_dwordx4 v4, s[20:23], s50 offen offset:1792 lds
    s_add_u32 m0, s49, 64768
    s_nop 0
    buffer_load_dwordx4 v5, s[20:23], s50 offen offset:1792 lds
    s_add_u32 m0, s49, 71936
    s_nop 0
    buffer_load_dwordx4 v4, s[20:23], s51 offen offset:1792 lds
    s_add_u32 m0, s49, 72960
    s_nop 0
    buffer_load_dwordx4 v5, s[20:23], s51 offen offset:1792 lds
    s_add_u32 m0, s49, 80128
    s_nop 0
    buffer_load_dwordx4 v4, s[20:23], s52 offen offset:1792 lds
    s_add_u32 m0, s49, 81152
    s_nop 0
    buffer_load_dwordx4 v5, s[20:23], s52 offen offset:1792 lds
    s_add_u32 m0, s49, 88320
    s_nop 0
    buffer_load_dwordx4 v4, s[20:23], s53 offen offset:1792 lds
    s_add_u32 m0, s49, 89344
    s_nop 0
    buffer_load_dwordx4 v5, s[20:23], s53 offen offset:1792 lds
    s_waitcnt vmcnt(16)
    s_barrier
    s_add_u32 m0, s49, 96512
    s_nop 0
    buffer_load_dwordx4 v4, s[20:23], s54 offen offset:1792 lds
    s_add_u32 m0, s49, 97536
    s_nop 0
    buffer_load_dwordx4 v5, s[20:23], s54 offen offset:1792 lds
    s_add_u32 m0, s49, 104704
    s_nop 0
    buffer_load_dwordx4 v4, s[20:23], s55 offen offset:1792 lds
    s_add_u32 m0, s49, 105728
    s_nop 0
    buffer_load_dwordx4 v5, s[20:23], s55 offen offset:1792 lds
    s_add_u32 m0, s49, 112896
    s_nop 0
    buffer_load_dwordx4 v4, s[20:23], s56 offen offset:1792 lds
    s_add_u32 m0, s49, 113920
    s_nop 0
    buffer_load_dwordx4 v5, s[20:23], s56 offen offset:1792 lds
    s_waitcnt vmcnt(14)
    s_barrier
    s_waitcnt vmcnt(6)
    s_barrier
    s_waitcnt vmcnt(0)
    s_barrier
    s_endpgm
L_k1_comp:
    s_cmp_lg_u32 s28, 0
    s_cbranch_scc1 L_k1_nocpf
    s_getpc_b64 s[44:45]
L_pca:
    s_add_u32 s44, s44, qkv_kernel-L_pca
    s_addc_u32 s45, s45, (qkv_kernel-L_pca)>>32
    v_lshlrev_b32 v252, 7, v0
    v_add_u32 v252, 0, v252
    v_min_u32 v252, L_k1_end-qkv_kernel-4, v252
    v_mov_b32 v253, s45
    v_add_co_u32 v252, vcc, s44, v252
    s_nop 1
    v_addc_co_u32 v253, vcc, 0, v253, vcc
    global_load_dword v254, v[252:253], off
    v_lshlrev_b32 v252, 7, v0
    v_add_u32 v252, 8192, v252
    v_min_u32 v252, L_k1_end-qkv_kernel-4, v252
    v_mov_b32 v253, s45
    v_add_co_u32 v252, vcc, s44, v252
    s_nop 1
    v_addc_co_u32 v253, vcc, 0, v253, vcc
    global_load_dword v254, v[252:253], off
L_k1_nocpf:
    v_and_b32 v20, 31, v0
    v_lshrrev_b32 v21, 5, v0
    v_bfe_u32 v22, v20, 1, 3
    v_xor_b32 v22, v22, v21
    s_lshl_b32 s36, s28, 12
    v_lshlrev_b32 v23, 7, v20
    v_add_u32 v23, s36, v23
    v_xor_b32 v24, 0, v22
    v_lshl_add_u32 v10, v24, 4, v23
    v_xor_b32 v24, 2, v22
    v_lshl_add_u32 v11, v24, 4, v23
    v_xor_b32 v24, 4, v22
    v_lshl_add_u32 v12, v24, 4, v23
    v_xor_b32 v24, 6, v22
    v_lshl_add_u32 v13, v24, 4, v23
    v_bfe_u32 v24, v0, 2, 2
    v_lshl_add_u32 v25, v21, 3, v24
    v_lshlrev_b32 v25, 7, v25
    v_lshrrev_b32 v24, 1, v24
    v_lshl_add_u32 v25, v24, 6, v25
    v_bfe_u32 v24, v0, 4, 1
    v_lshl_add_u32 v25, v24, 5, v25
    v_and_b32 v24, 3, v0
    v_lshl_add_u32 v14, v24, 3, v25
    v_xor_b32 v15, 64, v14
    v_add_u32 v16, 0x10000, v14
    v_add_u32 v17, 0x10000, v15
    v_add_u32 v18, 0x20000, v14
    v_add_u32 v19, 0x20000, v15
    v_add_u32 v2, 0x10000, v10
    v_add_u32 v6, 0x20000, v10
    v_add_u32 v3, 0x10000, v11
    v_add_u32 v7, 0x20000, v11
    v_add_u32 v4, 0x10000, v12
    v_add_u32 v8, 0x20000, v12
    v_add_u32 v5, 0x10000, v13
    v_add_u32 v9, 0x20000, v13
    s_lshl_b32 s36, s30, 4
    v_and_b32 v30, 1, v0
    v_lshl_add_u32 v31, v30, 1, v21
    v_and_b32 v30, 30, v20
    v_add_u32 v24, 0, v31
    v_add_u32 v24, s36, v24
    v_mul_u32_u24 v25, 147, v24
    v_lshrrev_b32 v25, 10, v25
    v_mul_u32_u24 v26, 7, v25
    v_sub_u32 v26, v24, v26
    v_lshlrev_b32 v27, 8, v26
    v_lshl_add_u32 v27, v30, 3, v27
    v_lshl_add_u32 v192, v25, 17, v27
    v_lshl_add_u32 v196, v25, 18, v27
    v_add_u32 v24, 4, v31
    v_add_u32 v24, s36, v24
    v_mul_u32_u24 v25, 147, v24
    v_lshrrev_b32 v25, 10, v25
    v_mul_u32_u24 v26, 7, v25
    v_sub_u32 v26, v24, v26
    v_lshlrev_b32 v27, 8, v26
    v_lshl_add_u32 v27, v30, 3, v27
    v_lshl_add_u32 v193, v25, 17, v27
    v_lshl_add_u32 v197, v25, 18, v27
    v_add_u32 v24, 8, v31
    v_add_u32 v24, s36, v24
    v_mul_u32_u24 v25, 147, v24
    v_lshrrev_b32 v25, 10, v25
    v_mul_u32_u24 v26, 7, v25
    v_sub_u32 v26, v24, v26
    v_lshlrev_b32 v27, 8, v26
    v_lshl_add_u32 v27, v30, 3, v27
    v_lshl_add_u32 v194, v25, 17, v27
    v_lshl_add_u32 v198, v25, 18, v27
    v_add_u32 v24, 12, v31
    v_add_u32 v24, s36, v24
    v_mul_u32_u24 v25, 147, v24
    v_lshrrev_b32 v25, 10, v25
    v_mul_u32_u24 v26, 7, v25
    v_sub_u32 v26, v24, v26
    v_lshlrev_b32 v27, 8, v26
    v_lshl_add_u32 v27, v30, 3, v27
    v_lshl_add_u32 v195, v25, 17, v27
    v_lshl_add_u32 v199, v25, 18, v27
    s_mov_b32 s56, 0x55555555
    s_mov_b32 s57, 0x55555555
    s_mov_b32 s58, 0xaaaaaaaa
    s_mov_b32 s59, 0xaaaaaaaa
    s_lshl_b32 s36, s30, 6
    v_add_u32 v24, 0, v20
    v_add_u32 v24, s36, v24
    v_mul_u32_u24 v25, 2341, v24
    v_lshrrev_b32 v25, 16, v25
    v_mul_u32_u24 v26, 28, v25
    v_sub_u32 v26, v24, v26
    v_bfe_u32 v27, v26, 3, 1
    v_xor_b32 v27, v27, v21
    v_lshlrev_b32 v27, 6, v27
    v_and_b32 v24, 3, v26
    v_lshl_add_u32 v27, v24, 4, v27
    v_lshrrev_b32 v26, 2, v26
    v_lshl_add_u32 v27, v26, 7, v27
    v_lshl_add_u32 v200, v25, 18, v27
    v_add_u32 v24, 32, v20
    v_add_u32 v24, s36, v24
    v_mul_u32_u24 v25, 2341, v24
    v_lshrrev_b32 v25, 16, v25
    v_mul_u32_u24 v26, 28, v25
    v_sub_u32 v26, v24, v26
    v_bfe_u32 v27, v26, 3, 1
    v_xor_b32 v27, v27, v21
    v_lshlrev_b32 v27, 6, v27
    v_and_b32 v24, 3, v26
    v_lshl_add_u32 v27, v24, 4, v27
    v_lshrrev_b32 v26, 2, v26
    v_lshl_add_u32 v27, v26, 7, v27
    v_lshl_add_u32 v201, v25, 18, v27
    s_mul_i32 s50, s29, 6291456
    s_lshl_b32 s51, s31, 2
    s_add_u32 s51, s51, s28
    s_lshl_b32 s52, s51, 11
    s_add_u32 s52, s52, s50
    s_lshl_b32 s54, s51, 12
    s_add_u32 s54, s54, s50
    s_add_u32 s54, s54, 2097152
    s_mov_b32 s55, 0x3e8b97f6
    s_cmp_eq_u32 s29, 0
    s_cselect_b32 s55, s55, 1.0
    s_waitcnt lgkmcnt(0)
    s_mov_b32 s24, s12
    s_mov_b32 s25, s13
    s_mov_b32 s26, 16777216
    s_mov_b32 s27, 0x00020000
    s_barrier
    ds_read_b128 v[32:35], v10 offset:0
    ds_read_b64_tr_b16 v[144:145], v14 offset:16384
    ds_read_b64_tr_b16 v[146:147], v14 offset:16896
    ds_read_b64_tr_b16 v[148:149], v15 offset:16384
    ds_read_b64_tr_b16 v[150:151], v15 offset:16896
    ds_read_b64_tr_b16 v[152:153], v14 offset:24576
    ds_read_b64_tr_b16 v[154:155], v14 offset:25088
    ds_read_b64_tr_b16 v[156:157], v15 offset:24576
    ds_read_b64_tr_b16 v[158:159], v15 offset:25088
    s_waitcnt lgkmcnt(0)
    v_mfma_f32_32x32x16_bf16 v[204:219], v[144:147], v[32:35], 0
    ds_read_b128 v[36:39], v11 offset:0
    ds_read_b64_tr_b16 v[160:161], v14 offset:18432
    ds_read_b64_tr_b16 v[162:163], v14 offset:18944
    v_mfma_f32_32x32x16_bf16 v[220:235], v[148:151], v[32:35], 0
    ds_read_b64_tr_b16 v[164:165], v15 offset:18432
    ds_read_b64_tr_b16 v[166:167], v15 offset:18944
    ds_read_b64_tr_b16 v[168:169], v14 offset:26624
    v_mfma_f32_32x32x16_bf16 v[236:251], v[152:155], v[32:35], 0
    ds_read_b64_tr_b16 v[170:171], v14 offset:27136
    ds_read_b64_tr_b16 v[172:173], v15 offset:26624
    ds_read_b64_tr_b16 v[174:175], v15 offset:27136
    v_mfma_f32_32x32x16_bf16 v[176:191], v[156:159], v[32:35], 0
    s_waitcnt lgkmcnt(0)
    v_mfma_f32_32x32x16_bf16 v[204:219], v[160:163], v[36:39], v[204:219]
    ds_read_b128 v[40:43], v12 offset:0
    ds_read_b64_tr_b16 v[144:145], v14 offset:20480
    ds_read_b64_tr_b16 v[146:147], v14 offset:20992
    v_mfma_f32_32x32x16_bf16 v[220:235], v[164:167], v[36:39], v[220:235]
    ds_read_b64_tr_b16 v[148:149], v15 offset:20480
    ds_read_b64_tr_b16 v[150:151], v15 offset:20992
    ds_read_b64_tr_b16 v[152:153], v14 offset:28672
    v_mfma_f32_32x32x16_bf16 v[236:251], v[168:171], v[36:39], v[236:251]
    ds_read_b64_tr_b16 v[154:155], v14 offset:29184
    ds_read_b64_tr_b16 v[156:157], v15 offset:28672
    ds_read_b64_tr_b16 v[158:159], v15 offset:29184
    v_mfma_f32_32x32x16_bf16 v[176:191], v[172:175], v[36:39], v[176:191]
    s_waitcnt lgkmcnt(0)
    v_mfma_f32_32x32x16_bf16 v[204:219], v[144:147], v[40:43], v[204:219]
    ds_read_b128 v[44:47], v13 offset:0
    ds_read_b64_tr_b16 v[160:161], v14 offset:22528
    ds_read_b64_tr_b16 v[162:163], v14 offset:23040
    v_mfma_f32_32x32x16_bf16 v[220:235], v[148:151], v[40:43], v[220:235]
    ds_read_b64_tr_b16 v[164:165], v15 offset:22528
    ds_read_b64_tr_b16 v[166:167], v15 offset:23040
    ds_read_b64_tr_b16 v[168:169], v14 offset:30720
    v_mfma_f32_32x32x16_bf16 v[236:251], v[152:155], v[40:43], v[236:251]
    ds_read_b64_tr_b16 v[170:171], v14 offset:31232
    ds_read_b64_tr_b16 v[172:173], v15 offset:30720
    ds_read_b64_tr_b16 v[174:175], v15 offset:31232
    v_mfma_f32_32x32x16_bf16 v[176:191], v[156:159], v[40:43], v[176:191]
    s_waitcnt lgkmcnt(0)
    s_barrier
    v_mfma_f32_32x32x16_bf16 v[204:219], v[160:163], v[44:47], v[204:219]
    ds_read_b128 v[48:51], v10 offset:32768
    ds_read_b64_tr_b16 v[144:145], v14 offset:49152
    ds_read_b64_tr_b16 v[146:147], v14 offset:49664
    v_mfma_f32_32x32x16_bf16 v[220:235], v[164:167], v[44:47], v[220:235]
    ds_read_b64_tr_b16 v[148:149], v15 offset:49152
    ds_read_b64_tr_b16 v[150:151], v15 offset:49664
    ds_read_b64_tr_b16 v[152:153], v14 offset:57344
    v_mfma_f32_32x32x16_bf16 v[236:251], v[168:171], v[44:47], v[236:251]
    ds_read_b64_tr_b16 v[154:155], v14 offset:57856
    ds_read_b64_tr_b16 v[156:157], v15 offset:57344
    ds_read_b64_tr_b16 v[158:159], v15 offset:57856
    v_mfma_f32_32x32x16_bf16 v[176:191], v[172:175], v[44:47], v[176:191]
    s_waitcnt lgkmcnt(0)
    v_mfma_f32_32x32x16_bf16 v[204:219], v[144:147], v[48:51], v[204:219]
    ds_read_b128 v[52:55], v11 offset:32768
    ds_read_b64_tr_b16 v[160:161], v14 offset:51200
    ds_read_b64_tr_b16 v[162:163], v14 offset:51712
    v_mfma_f32_32x32x16_bf16 v[220:235], v[148:151], v[48:51], v[220:235]
    ds_read_b64_tr_b16 v[164:165], v15 offset:51200
    ds_read_b64_tr_b16 v[166:167], v15 offset:51712
    ds_read_b64_tr_b16 v[168:169], v14 offset:59392
    v_mfma_f32_32x32x16_bf16 v[236:251], v[152:155], v[48:51], v[236:251]
    ds_read_b64_tr_b16 v[170:171], v14 offset:59904
    ds_read_b64_tr_b16 v[172:173], v15 offset:59392
    ds_read_b64_tr_b16 v[174:175], v15 offset:59904
    v_mfma_f32_32x32x16_bf16 v[176:191], v[156:159], v[48:51], v[176:191]
    s_waitcnt lgkmcnt(0)
    v_mfma_f32_32x32x16_bf16 v[204:219], v[160:163], v[52:55], v[204:219]
    ds_read_b128 v[56:59], v12 offset:32768
    ds_read_b64_tr_b16 v[144:145], v14 offset:53248
    ds_read_b64_tr_b16 v[146:147], v14 offset:53760
    v_mfma_f32_32x32x16_bf16 v[220:235], v[164:167], v[52:55], v[220:235]
    ds_read_b64_tr_b16 v[148:149], v15 offset:53248
    ds_read_b64_tr_b16 v[150:151], v15 offset:53760
    ds_read_b64_tr_b16 v[152:153], v14 offset:61440
    v_mfma_f32_32x32x16_bf16 v[236:251], v[168:171], v[52:55], v[236:251]
    ds_read_b64_tr_b16 v[154:155], v14 offset:61952
    ds_read_b64_tr_b16 v[156:157], v15 offset:61440
    ds_read_b64_tr_b16 v[158:159], v15 offset:61952
    v_mfma_f32_32x32x16_bf16 v[176:191], v[172:175], v[52:55], v[176:191]
    s_waitcnt lgkmcnt(0)
    v_mfma_f32_32x32x16_bf16 v[204:219], v[144:147], v[56:59], v[204:219]
    ds_read_b128 v[60:63], v13 offset:32768
    ds_read_b64_tr_b16 v[160:161], v14 offset:55296
    ds_read_b64_tr_b16 v[162:163], v14 offset:55808
    v_mfma_f32_32x32x16_bf16 v[220:235], v[148:151], v[56:59], v[220:235]
    ds_read_b64_tr_b16 v[164:165], v15 offset:55296
    ds_read_b64_tr_b16 v[166:167], v15 offset:55808
    ds_read_b64_tr_b16 v[168:169], v14 offset:63488
    v_mfma_f32_32x32x16_bf16 v[236:251], v[152:155], v[56:59], v[236:251]
    ds_read_b64_tr_b16 v[170:171], v14 offset:64000
    ds_read_b64_tr_b16 v[172:173], v15 offset:63488
    ds_read_b64_tr_b16 v[174:175], v15 offset:64000
    v_mfma_f32_32x32x16_bf16 v[176:191], v[156:159], v[56:59], v[176:191]
    s_waitcnt lgkmcnt(0)
    s_barrier
    v_mfma_f32_32x32x16_bf16 v[204:219], v[160:163], v[60:63], v[204:219]
    ds_read_b128 v[64:67], v2 offset:0
    ds_read_b64_tr_b16 v[144:145], v16 offset:16384
    ds_read_b64_tr_b16 v[146:147], v16 offset:16896
    v_mfma_f32_32x32x16_bf16 v[220:235], v[164:167], v[60:63], v[220:235]
    ds_read_b64_tr_b16 v[148:149], v17 offset:16384
    ds_read_b64_tr_b16 v[150:151], v17 offset:16896
    ds_read_b64_tr_b16 v[152:153], v16 offset:24576
    v_mfma_f32_32x32x16_bf16 v[236:251], v[168:171], v[60:63], v[236:251]
    ds_read_b64_tr_b16 v[154:155], v16 offset:25088
    ds_read_b64_tr_b16 v[156:157], v17 offset:24576
    ds_read_b64_tr_b16 v[158:159], v17 offset:25088
    v_mfma_f32_32x32x16_bf16 v[176:191], v[172:175], v[60:63], v[176:191]
    s_waitcnt lgkmcnt(0)
    v_mfma_f32_32x32x16_bf16 v[204:219], v[144:147], v[64:67], v[204:219]
    ds_read_b128 v[68:71], v3 offset:0
    ds_read_b64_tr_b16 v[160:161], v16 offset:18432
    ds_read_b64_tr_b16 v[162:163], v16 offset:18944
    v_mfma_f32_32x32x16_bf16 v[220:235], v[148:151], v[64:67], v[220:235]
    ds_read_b64_tr_b16 v[164:165], v17 offset:18432
    ds_read_b64_tr_b16 v[166:167], v17 offset:18944
    ds_read_b64_tr_b16 v[168:169], v16 offset:26624
    v_mfma_f32_32x32x16_bf16 v[236:251], v[152:155], v[64:67], v[236:251]
    ds_read_b64_tr_b16 v[170:171], v16 offset:27136
    ds_read_b64_tr_b16 v[172:173], v17 offset:26624
    ds_read_b64_tr_b16 v[174:175], v17 offset:27136
    v_mfma_f32_32x32x16_bf16 v[176:191], v[156:159], v[64:67], v[176:191]
    s_waitcnt lgkmcnt(0)
    v_mfma_f32_32x32x16_bf16 v[204:219], v[160:163], v[68:71], v[204:219]
    ds_read_b128 v[72:75], v4 offset:0
    ds_read_b64_tr_b16 v[144:145], v16 offset:20480
    ds_read_b64_tr_b16 v[146:147], v16 offset:20992
    v_mfma_f32_32x32x16_bf16 v[220:235], v[164:167], v[68:71], v[220:235]
    ds_read_b64_tr_b16 v[148:149], v17 offset:20480
    ds_read_b64_tr_b16 v[150:151], v17 offset:20992
    ds_read_b64_tr_b16 v[152:153], v16 offset:28672
    v_mfma_f32_32x32x16_bf16 v[236:251], v[168:171], v[68:71], v[236:251]
    ds_read_b64_tr_b16 v[154:155], v16 offset:29184
    ds_read_b64_tr_b16 v[156:157], v17 offset:28672
    ds_read_b64_tr_b16 v[158:159], v17 offset:29184
    v_mfma_f32_32x32x16_bf16 v[176:191], v[172:175], v[68:71], v[176:191]
    s_waitcnt lgkmcnt(0)
    v_mfma_f32_32x32x16_bf16 v[204:219], v[144:147], v[72:75], v[204:219]
    ds_read_b128 v[76:79], v5 offset:0
    ds_read_b64_tr_b16 v[160:161], v16 offset:22528
    ds_read_b64_tr_b16 v[162:163], v16 offset:23040
    v_mfma_f32_32x32x16_bf16 v[220:235], v[148:151], v[72:75], v[220:235]
    ds_read_b64_tr_b16 v[164:165], v17 offset:22528
    ds_read_b64_tr_b16 v[166:167], v17 offset:23040
    ds_read_b64_tr_b16 v[168:169], v16 offset:30720
    v_mfma_f32_32x32x16_bf16 v[236:251], v[152:155], v[72:75], v[236:251]
    ds_read_b64_tr_b16 v[170:171], v16 offset:31232
    ds_read_b64_tr_b16 v[172:173], v17 offset:30720
    ds_read_b64_tr_b16 v[174:175], v17 offset:31232
    v_mfma_f32_32x32x16_bf16 v[176:191], v[156:159], v[72:75], v[176:191]
    s_waitcnt lgkmcnt(0)
    s_barrier
    v_mfma_f32_32x32x16_bf16 v[204:219], v[160:163], v[76:79], v[204:219]
    ds_read_b128 v[80:83], v2 offset:32768
    ds_read_b64_tr_b16 v[144:145], v16 offset:49152
    ds_read_b64_tr_b16 v[146:147], v16 offset:49664
    v_mfma_f32_32x32x16_bf16 v[220:235], v[164:167], v[76:79], v[220:235]
    ds_read_b64_tr_b16 v[148:149], v17 offset:49152
    ds_read_b64_tr_b16 v[150:151], v17 offset:49664
    ds_read_b64_tr_b16 v[152:153], v16 offset:57344
    v_mfma_f32_32x32x16_bf16 v[236:251], v[168:171], v[76:79], v[236:251]
    ds_read_b64_tr_b16 v[154:155], v16 offset:57856
    ds_read_b64_tr_b16 v[156:157], v17 offset:57344
    ds_read_b64_tr_b16 v[158:159], v17 offset:57856
    v_mfma_f32_32x32x16_bf16 v[176:191], v[172:175], v[76:79], v[176:191]
    s_waitcnt lgkmcnt(0)
    v_mfma_f32_32x32x16_bf16 v[204:219], v[144:147], v[80:83], v[204:219]
    ds_read_b128 v[84:87], v3 offset:32768
    ds_read_b64_tr_b16 v[160:161], v16 offset:51200
    ds_read_b64_tr_b16 v[162:163], v16 offset:51712
    v_mfma_f32_32x32x16_bf16 v[220:235], v[148:151], v[80:83], v[220:235]
    ds_read_b64_tr_b16 v[164:165], v17 offset:51200
    ds_read_b64_tr_b16 v[166:167], v17 offset:51712
    ds_read_b64_tr_b16 v[168:169], v16 offset:59392
    v_mfma_f32_32x32x16_bf16 v[236:251], v[152:155], v[80:83], v[236:251]
    ds_read_b64_tr_b16 v[170:171], v16 offset:59904
    ds_read_b64_tr_b16 v[172:173], v17 offset:59392
    ds_read_b64_tr_b16 v[174:175], v17 offset:59904
    v_mfma_f32_32x32x16_bf16 v[176:191], v[156:159], v[80:83], v[176:191]
    s_waitcnt lgkmcnt(0)
    v_mfma_f32_32x32x16_bf16 v[204:219], v[160:163], v[84:87], v[204:219]
    ds_read_b128 v[88:91], v4 offset:32768
    ds_read_b64_tr_b16 v[144:145], v16 offset:53248
    ds_read_b64_tr_b16 v[146:147], v16 offset:53760
    v_mfma_f32_32x32x16_bf16 v[220:235], v[164:167], v[84:87], v[220:235]
    ds_read_b64_tr_b16 v[148:149], v17 offset:53248
    ds_read_b64_tr_b16 v[150:151], v17 offset:53760
    ds_read_b64_tr_b16 v[152:153], v16 offset:61440
    v_mfma_f32_32x32x16_bf16 v[236:251], v[168:171], v[84:87], v[236:251]
    ds_read_b64_tr_b16 v[154:155], v16 offset:61952
    ds_read_b64_tr_b16 v[156:157], v17 offset:61440
    ds_read_b64_tr_b16 v[158:159], v17 offset:61952
    v_mfma_f32_32x32x16_bf16 v[176:191], v[172:175], v[84:87], v[176:191]
    s_waitcnt lgkmcnt(0)
    v_mfma_f32_32x32x16_bf16 v[204:219], v[144:147], v[88:91], v[204:219]
    ds_read_b128 v[92:95], v5 offset:32768
    ds_read_b64_tr_b16 v[160:161], v16 offset:55296
    ds_read_b64_tr_b16 v[162:163], v16 offset:55808
    v_mfma_f32_32x32x16_bf16 v[220:235], v[148:151], v[88:91], v[220:235]
    ds_read_b64_tr_b16 v[164:165], v17 offset:55296
    ds_read_b64_tr_b16 v[166:167], v17 offset:55808
    ds_read_b64_tr_b16 v[168:169], v16 offset:63488
    v_mfma_f32_32x32x16_bf16 v[236:251], v[152:155], v[88:91], v[236:251]
    ds_read_b64_tr_b16 v[170:171], v16 offset:64000
    ds_read_b64_tr_b16 v[172:173], v17 offset:63488
    ds_read_b64_tr_b16 v[174:175], v17 offset:64000
    v_mfma_f32_32x32x16_bf16 v[176:191], v[156:159], v[88:91], v[176:191]
    s_waitcnt lgkmcnt(0)
    s_barrier
    v_mfma_f32_32x32x16_bf16 v[204:219], v[160:163], v[92:95], v[204:219]
    ds_read_b128 v[96:99], v6 offset:0
    ds_read_b64_tr_b16 v[144:145], v18 offset:16384
    ds_read_b64_tr_b16 v[146:147], v18 offset:16896
    v_mfma_f32_32x32x16_bf16 v[220:235], v[164:167], v[92:95], v[220:235]
    ds_read_b64_tr_b16 v[148:149], v19 offset:16384
    ds_read_b64_tr_b16 v[150:151], v19 offset:16896
    ds_read_b64_tr_b16 v[152:153], v18 offset:24576
    v_mfma_f32_32x32x16_bf16 v[236:251], v[168:171], v[92:95], v[236:251]
    ds_read_b64_tr_b16 v[154:155], v18 offset:25088
    ds_read_b64_tr_b16 v[156:157], v19 offset:24576
    ds_read_b64_tr_b16 v[158:159], v19 offset:25088
    v_mfma_f32_32x32x16_bf16 v[176:191], v[172:175], v[92:95], v[176:191]
    s_waitcnt lgkmcnt(0)
    v_mfma_f32_32x32x16_bf16 v[204:219], v[144:147], v[96:99], v[204:219]
    ds_read_b128 v[100:103], v7 offset:0
    ds_read_b64_tr_b16 v[160:161], v18 offset:18432
    ds_read_b64_tr_b16 v[162:163], v18 offset:18944
    v_mfma_f32_32x32x16_bf16 v[220:235], v[148:151], v[96:99], v[220:235]
    ds_read_b64_tr_b16 v[164:165], v19 offset:18432
    ds_read_b64_tr_b16 v[166:167], v19 offset:18944
    ds_read_b64_tr_b16 v[168:169], v18 offset:26624
    v_mfma_f32_32x32x16_bf16 v[236:251], v[152:155], v[96:99], v[236:251]
    ds_read_b64_tr_b16 v[170:171], v18 offset:27136
    ds_read_b64_tr_b16 v[172:173], v19 offset:26624
    ds_read_b64_tr_b16 v[174:175], v19 offset:27136
    v_mfma_f32_32x32x16_bf16 v[176:191], v[156:159], v[96:99], v[176:191]
    s_waitcnt lgkmcnt(0)
    v_mfma_f32_32x32x16_bf16 v[204:219], v[160:163], v[100:103], v[204:219]
    ds_read_b128 v[104:107], v8 offset:0
    ds_read_b64_tr_b16 v[144:145], v18 offset:20480
    ds_read_b64_tr_b16 v[146:147], v18 offset:20992
    v_mfma_f32_32x32x16_bf16 v[220:235], v[164:167], v[100:103], v[220:235]
    ds_read_b64_tr_b16 v[148:149], v19 offset:20480
    ds_read_b64_tr_b16 v[150:151], v19 offset:20992
    ds_read_b64_tr_b16 v[152:153], v18 offset:28672
    v_mfma_f32_32x32x16_bf16 v[236:251], v[168:171], v[100:103], v[236:251]
    ds_read_b64_tr_b16 v[154:155], v18 offset:29184
    ds_read_b64_tr_b16 v[156:157], v19 offset:28672
    ds_read_b64_tr_b16 v[158:159], v19 offset:29184
    v_mfma_f32_32x32x16_bf16 v[176:191], v[172:175], v[100:103], v[176:191]
    s_waitcnt lgkmcnt(0)
    v_mfma_f32_32x32x16_bf16 v[204:219], v[144:147], v[104:107], v[204:219]
    ds_read_b128 v[108:111], v9 offset:0
    ds_read_b64_tr_b16 v[160:161], v18 offset:22528
    ds_read_b64_tr_b16 v[162:163], v18 offset:23040
    v_mfma_f32_32x32x16_bf16 v[220:235], v[148:151], v[104:107], v[220:235]
    ds_read_b64_tr_b16 v[164:165], v19 offset:22528
    ds_read_b64_tr_b16 v[166:167], v19 offset:23040
    ds_read_b64_tr_b16 v[168:169], v18 offset:30720
    v_mfma_f32_32x32x16_bf16 v[236:251], v[152:155], v[104:107], v[236:251]
    ds_read_b64_tr_b16 v[170:171], v18 offset:31232
    ds_read_b64_tr_b16 v[172:173], v19 offset:30720
    ds_read_b64_tr_b16 v[174:175], v19 offset:31232
    v_mfma_f32_32x32x16_bf16 v[176:191], v[156:159], v[104:107], v[176:191]
    s_waitcnt lgkmcnt(0)
    s_barrier
    v_mfma_f32_32x32x16_bf16 v[204:219], v[160:163], v[108:111], v[204:219]
    ds_read_b128 v[112:115], v10 offset:0
    ds_read_b64_tr_b16 v[144:145], v14 offset:16384
    ds_read_b64_tr_b16 v[146:147], v14 offset:16896
    v_mfma_f32_32x32x16_bf16 v[220:235], v[164:167], v[108:111], v[220:235]
    ds_read_b64_tr_b16 v[148:149], v15 offset:16384
    ds_read_b64_tr_b16 v[150:151], v15 offset:16896
    ds_read_b64_tr_b16 v[152:153], v14 offset:24576
    v_mfma_f32_32x32x16_bf16 v[236:251], v[168:171], v[108:111], v[236:251]
    ds_read_b64_tr_b16 v[154:155], v14 offset:25088
    ds_read_b64_tr_b16 v[156:157], v15 offset:24576
    ds_read_b64_tr_b16 v[158:159], v15 offset:25088
    v_mfma_f32_32x32x16_bf16 v[176:191], v[172:175], v[108:111], v[176:191]
    s_waitcnt lgkmcnt(0)
    v_mfma_f32_32x32x16_bf16 v[204:219], v[144:147], v[112:115], v[204:219]
    ds_read_b128 v[116:119], v11 offset:0
    ds_read_b64_tr_b16 v[160:161], v14 offset:18432
    ds_read_b64_tr_b16 v[162:163], v14 offset:18944
    v_mfma_f32_32x32x16_bf16 v[220:235], v[148:151], v[112:115], v[220:235]
    ds_read_b64_tr_b16 v[164:165], v15 offset:18432
    ds_read_b64_tr_b16 v[166:167], v15 offset:18944
    ds_read_b64_tr_b16 v[168:169], v14 offset:26624
    v_mfma_f32_32x32x16_bf16 v[236:251], v[152:155], v[112:115], v[236:251]
    ds_read_b64_tr_b16 v[170:171], v14 offset:27136
    ds_read_b64_tr_b16 v[172:173], v15 offset:26624
    ds_read_b64_tr_b16 v[174:175], v15 offset:27136
    v_mfma_f32_32x32x16_bf16 v[176:191], v[156:159], v[112:115], v[176:191]
    s_waitcnt lgkmcnt(0)
    v_mfma_f32_32x32x16_bf16 v[204:219], v[160:163], v[116:119], v[204:219]
    ds_read_b128 v[120:123], v12 offset:0
    ds_read_b64_tr_b16 v[144:145], v14 offset:20480
    ds_read_b64_tr_b16 v[146:147], v14 offset:20992
    v_mfma_f32_32x32x16_bf16 v[220:235], v[164:167], v[116:119], v[220:235]
    ds_read_b64_tr_b16 v[148:149], v15 offset:20480
    ds_read_b64_tr_b16 v[150:151], v15 offset:20992
    ds_read_b64_tr_b16 v[152:153], v14 offset:28672
    v_mfma_f32_32x32x16_bf16 v[236:251], v[168:171], v[116:119], v[236:251]
    ds_read_b64_tr_b16 v[154:155], v14 offset:29184
    ds_read_b64_tr_b16 v[156:157], v15 offset:28672
    ds_read_b64_tr_b16 v[158:159], v15 offset:29184
    v_mfma_f32_32x32x16_bf16 v[176:191], v[172:175], v[116:119], v[176:191]
    s_waitcnt lgkmcnt(0)
    v_mfma_f32_32x32x16_bf16 v[204:219], v[144:147], v[120:123], v[204:219]
    ds_read_b128 v[124:127], v13 offset:0
    ds_read_b64_tr_b16 v[160:161], v14 offset:22528
    ds_read_b64_tr_b16 v[162:163], v14 offset:23040
    v_mfma_f32_32x32x16_bf16 v[220:235], v[148:151], v[120:123], v[220:235]
    ds_read_b64_tr_b16 v[164:165], v15 offset:22528
    ds_read_b64_tr_b16 v[166:167], v15 offset:23040
    ds_read_b64_tr_b16 v[168:169], v14 offset:30720
    v_mfma_f32_32x32x16_bf16 v[236:251], v[152:155], v[120:123], v[236:251]
    ds_read_b64_tr_b16 v[170:171], v14 offset:31232
    ds_read_b64_tr_b16 v[172:173], v15 offset:30720
    ds_read_b64_tr_b16 v[174:175], v15 offset:31232
    v_mfma_f32_32x32x16_bf16 v[176:191], v[156:159], v[120:123], v[176:191]
    s_waitcnt lgkmcnt(0)
    s_barrier
    v_mfma_f32_32x32x16_bf16 v[204:219], v[160:163], v[124:127], v[204:219]
    ds_read_b128 v[128:131], v10 offset:32768
    ds_read_b64_tr_b16 v[144:145], v14 offset:49152
    ds_read_b64_tr_b16 v[146:147], v14 offset:49664
    v_mfma_f32_32x32x16_bf16 v[220:235], v[164:167], v[124:127], v[220:235]
    ds_read_b64_tr_b16 v[148:149], v15 offset:49152
    ds_read_b64_tr_b16 v[150:151], v15 offset:49664
    ds_read_b64_tr_b16 v[152:153], v14 offset:57344
    v_mfma_f32_32x32x16_bf16 v[236:251], v[168:171], v[124:127], v[236:251]
    ds_read_b64_tr_b16 v[154:155], v14 offset:57856
    ds_read_b64_tr_b16 v[156:157], v15 offset:57344
    ds_read_b64_tr_b16 v[158:159], v15 offset:57856
    v_mfma_f32_32x32x16_bf16 v[176:191], v[172:175], v[124:127], v[176:191]
    s_waitcnt lgkmcnt(0)
    v_mfma_f32_32x32x16_bf16 v[204:219], v[144:147], v[128:131], v[204:219]
    ds_read_b128 v[132:135], v11 offset:32768
    ds_read_b64_tr_b16 v[160:161], v14 offset:51200
    ds_read_b64_tr_b16 v[162:163], v14 offset:51712
    v_mfma_f32_32x32x16_bf16 v[220:235], v[148:151], v[128:131], v[220:235]
    ds_read_b64_tr_b16 v[164:165], v15 offset:51200
    ds_read_b64_tr_b16 v[166:167], v15 offset:51712
    ds_read_b64_tr_b16 v[168:169], v14 offset:59392
    v_mfma_f32_32x32x16_bf16 v[236:251], v[152:155], v[128:131], v[236:251]
    ds_read_b64_tr_b16 v[170:171], v14 offset:59904
    ds_read_b64_tr_b16 v[172:173], v15 offset:59392
    ds_read_b64_tr_b16 v[174:175], v15 offset:59904
    v_mfma_f32_32x32x16_bf16 v[176:191], v[156:159], v[128:131], v[176:191]
    s_waitcnt lgkmcnt(0)
    v_mfma_f32_32x32x16_bf16 v[204:219], v[160:163], v[132:135], v[204:219]
    ds_read_b128 v[136:139], v12 offset:32768
    ds_read_b64_tr_b16 v[144:145], v14 offset:53248
    ds_read_b64_tr_b16 v[146:147], v14 offset:53760
    v_mfma_f32_32x32x16_bf16 v[220:235], v[164:167], v[132:135], v[220:235]
    ds_read_b64_tr_b16 v[148:149], v15 offset:53248
    ds_read_b64_tr_b16 v[150:151], v15 offset:53760
    ds_read_b64_tr_b16 v[152:153], v14 offset:61440
    v_mfma_f32_32x32x16_bf16 v[236:251], v[168:171], v[132:135], v[236:251]
    ds_read_b64_tr_b16 v[154:155], v14 offset:61952
    ds_read_b64_tr_b16 v[156:157], v15 offset:61440
    ds_read_b64_tr_b16 v[158:159], v15 offset:61952
    v_mfma_f32_32x32x16_bf16 v[176:191], v[172:175], v[132:135], v[176:191]
    s_waitcnt lgkmcnt(0)
    v_mfma_f32_32x32x16_bf16 v[204:219], v[144:147], v[136:139], v[204:219]
    ds_read_b128 v[140:143], v13 offset:32768
    ds_read_b64_tr_b16 v[160:161], v14 offset:55296
    ds_read_b64_tr_b16 v[162:163], v14 offset:55808
    v_mfma_f32_32x32x16_bf16 v[220:235], v[148:151], v[136:139], v[220:235]
    ds_read_b64_tr_b16 v[164:165], v15 offset:55296
    ds_read_b64_tr_b16 v[166:167], v15 offset:55808
    ds_read_b64_tr_b16 v[168:169], v14 offset:63488
    v_mfma_f32_32x32x16_bf16 v[236:251], v[152:155], v[136:139], v[236:251]
    ds_read_b64_tr_b16 v[170:171], v14 offset:64000
    ds_read_b64_tr_b16 v[172:173], v15 offset:63488
    ds_read_b64_tr_b16 v[174:175], v15 offset:64000
    v_mfma_f32_32x32x16_bf16 v[176:191], v[156:159], v[136:139], v[176:191]
    s_waitcnt lgkmcnt(0)
    s_barrier
    v_mfma_f32_32x32x16_bf16 v[204:219], v[160:163], v[140:143], v[204:219]
    v_mfma_f32_32x32x16_bf16 v[220:235], v[164:167], v[140:143], v[220:235]
    v_mfma_f32_32x32x16_bf16 v[236:251], v[168:171], v[140:143], v[236:251]
    v_mfma_f32_32x32x16_bf16 v[176:191], v[172:175], v[140:143], v[176:191]
    ds_read_b64_tr_b16 v[144:145], v16 offset:0
    ds_read_b64_tr_b16 v[146:147], v16 offset:512
    ds_read_b64_tr_b16 v[148:149], v16 offset:2048
    ds_read_b64_tr_b16 v[150:151], v16 offset:2560
    ds_read_b64_tr_b16 v[152:153], v16 offset:4096
    ds_read_b64_tr_b16 v[154:155], v16 offset:4608
    s_waitcnt lgkmcnt(4)
    v_mfma_f32_32x32x16_bf16 v[160:175], v[32:35], v[144:147], 0
    ds_read_b64_tr_b16 v[156:157], v16 offset:6144
    ds_read_b64_tr_b16 v[158:159], v16 offset:6656
    s_waitcnt lgkmcnt(4)
    v_mfma_f32_32x32x16_bf16 v[160:175], v[36:39], v[148:151], v[160:175]
    ds_read_b64_tr_b16 v[144:145], v16 offset:8192
    ds_read_b64_tr_b16 v[146:147], v16 offset:8704
    s_waitcnt lgkmcnt(4)
    v_mfma_f32_32x32x16_bf16 v[160:175], v[40:43], v[152:155], v[160:175]
    ds_read_b64_tr_b16 v[148:149], v16 offset:10240
    ds_read_b64_tr_b16 v[150:151], v16 offset:10752
    s_waitcnt lgkmcnt(4)
    v_mfma_f32_32x32x16_bf16 v[160:175], v[44:47], v[156:159], v[160:175]
    ds_read_b64_tr_b16 v[152:153], v16 offset:12288
    ds_read_b64_tr_b16 v[154:155], v16 offset:12800
    v_mul_f32 v204, s55, v204
    v_mul_f32 v205, s55, v205
    v_mul_f32 v206, s55, v206
    v_mul_f32 v207, s55, v207
    s_waitcnt lgkmcnt(4)
    v_mfma_f32_32x32x16_bf16 v[160:175], v[48:51], v[144:147], v[160:175]
    ds_read_b64_tr_b16 v[156:157], v16 offset:14336
    ds_read_b64_tr_b16 v[158:159], v16 offset:14848
    v_mul_f32 v208, s55, v208
    v_mul_f32 v209, s55, v209
    v_mul_f32 v210, s55, v210
    v_mul_f32 v211, s55, v211
    s_waitcnt lgkmcnt(4)
    v_mfma_f32_32x32x16_bf16 v[160:175], v[52:55], v[148:151], v[160:175]
    ds_read_b64_tr_b16 v[144:145], v16 offset:16384
    ds_read_b64_tr_b16 v[146:147], v16 offset:16896
    v_mul_f32 v212, s55, v212
    v_mul_f32 v213, s55, v213
    v_mul_f32 v214, s55, v214
    v_mul_f32 v215, s55, v215
    s_waitcnt lgkmcnt(4)
    v_mfma_f32_32x32x16_bf16 v[160:175], v[56:59], v[152:155], v[160:175]
    ds_read_b64_tr_b16 v[148:149], v16 offset:18432
    ds_read_b64_tr_b16 v[150:151], v16 offset:18944
    v_mul_f32 v216, s55, v216
    v_mul_f32 v217, s55, v217
    v_mul_f32 v218, s55, v218
    v_mul_f32 v219, s55, v219
    s_waitcnt lgkmcnt(4)
    v_mfma_f32_32x32x16_bf16 v[160:175], v[60:63], v[156:159], v[160:175]
    ds_read_b64_tr_b16 v[152:153], v16 offset:20480
    ds_read_b64_tr_b16 v[154:155], v16 offset:20992
    v_cvt_pk_bf16_f32 v204, v204, v205
    v_cvt_pk_bf16_f32 v205, v206, v207
    v_cvt_pk_bf16_f32 v206, v208, v209
    v_cvt_pk_bf16_f32 v207, v210, v211
    s_waitcnt lgkmcnt(4)
    v_mfma_f32_32x32x16_bf16 v[160:175], v[64:67], v[144:147], v[160:175]
    ds_read_b64_tr_b16 v[156:157], v16 offset:22528
    ds_read_b64_tr_b16 v[158:159], v16 offset:23040
    v_cvt_pk_bf16_f32 v208, v212, v213
    v_cvt_pk_bf16_f32 v209, v214, v215
    v_cvt_pk_bf16_f32 v210, v216, v217
    v_cvt_pk_bf16_f32 v211, v218, v219
    s_waitcnt lgkmcnt(4)
    v_mfma_f32_32x32x16_bf16 v[160:175], v[68:71], v[148:151], v[160:175]
    ds_read_b64_tr_b16 v[144:145], v16 offset:24576
    ds_read_b64_tr_b16 v[146:147], v16 offset:25088
    s_mov_b64 vcc, s[56:57]
    s_nop 0
    v_cndmask_b32_dpp v212, v206, v204, vcc quad_perm:[1,0,3,2] row_mask:0xf bank_mask:0xf
    v_cndmask_b32_dpp v213, v207, v205, vcc quad_perm:[1,0,3,2] row_mask:0xf bank_mask:0xf
    s_waitcnt lgkmcnt(4)
    v_mfma_f32_32x32x16_bf16 v[160:175], v[72:75], v[152:155], v[160:175]
    ds_read_b64_tr_b16 v[148:149], v16 offset:26624
    ds_read_b64_tr_b16 v[150:151], v16 offset:27136
    v_cndmask_b32_dpp v216, v210, v208, vcc quad_perm:[1,0,3,2] row_mask:0xf bank_mask:0xf
    v_cndmask_b32_dpp v217, v211, v209, vcc quad_perm:[1,0,3,2] row_mask:0xf bank_mask:0xf
    s_mov_b64 vcc, s[58:59]
    s_nop 0
    s_waitcnt lgkmcnt(4)
    v_mfma_f32_32x32x16_bf16 v[160:175], v[76:79], v[156:159], v[160:175]
    ds_read_b64_tr_b16 v[152:153], v16 offset:28672
    ds_read_b64_tr_b16 v[154:155], v16 offset:29184
    v_cndmask_b32_dpp v214, v204, v206, vcc quad_perm:[1,0,3,2] row_mask:0xf bank_mask:0xf
    v_cndmask_b32_dpp v215, v205, v207, vcc quad_perm:[1,0,3,2] row_mask:0xf bank_mask:0xf
    v_cndmask_b32_dpp v218, v208, v210, vcc quad_perm:[1,0,3,2] row_mask:0xf bank_mask:0xf
    v_cndmask_b32_dpp v219, v209, v211, vcc quad_perm:[1,0,3,2] row_mask:0xf bank_mask:0xf
    s_waitcnt lgkmcnt(4)
    v_mfma_f32_32x32x16_bf16 v[160:175], v[80:83], v[144:147], v[160:175]
    ds_read_b64_tr_b16 v[156:157], v16 offset:30720
    ds_read_b64_tr_b16 v[158:159], v16 offset:31232
    buffer_store_dwordx4 v[212:215], v192, s[24:27], s52 offen sc1
    buffer_store_dwordx4 v[216:219], v193, s[24:27], s52 offen sc1
    v_mul_f32 v220, s55, v220
    v_mul_f32 v221, s55, v221
    s_barrier
    s_waitcnt lgkmcnt(4)
    v_mfma_f32_32x32x16_bf16 v[160:175], v[84:87], v[148:151], v[160:175]
    ds_read_b64_tr_b16 v[144:145], v16 offset:32768
    ds_read_b64_tr_b16 v[146:147], v16 offset:33280
    v_mul_f32 v222, s55, v222
    v_mul_f32 v223, s55, v223
    v_mul_f32 v224, s55, v224
    v_mul_f32 v225, s55, v225
    s_waitcnt lgkmcnt(4)
    v_mfma_f32_32x32x16_bf16 v[160:175], v[88:91], v[152:155], v[160:175]
    ds_read_b64_tr_b16 v[148:149], v16 offset:34816
    ds_read_b64_tr_b16 v[150:151], v16 offset:35328
    v_mul_f32 v226, s55, v226
    v_mul_f32 v227, s55, v227
    v_mul_f32 v228, s55, v228
    v_mul_f32 v229, s55, v229
    s_waitcnt lgkmcnt(4)
    v_mfma_f32_32x32x16_bf16 v[160:175], v[92:95], v[156:159], v[160:175]
    ds_read_b64_tr_b16 v[152:153], v16 offset:36864
    ds_read_b64_tr_b16 v[154:155], v16 offset:37376
    v_mul_f32 v230, s55, v230
    v_mul_f32 v231, s55, v231
    v_mul_f32 v232, s55, v232
    v_mul_f32 v233, s55, v233
    s_waitcnt lgkmcnt(4)
    v_mfma_f32_32x32x16_bf16 v[160:175], v[96:99], v[144:147], v[160:175]
    ds_read_b64_tr_b16 v[156:157], v16 offset:38912
    ds_read_b64_tr_b16 v[158:159], v16 offset:39424
    v_mul_f32 v234, s55, v234
    v_mul_f32 v235, s55, v235
    v_cvt_pk_bf16_f32 v220, v220, v221
    v_cvt_pk_bf16_f32 v221, v222, v223
    s_waitcnt lgkmcnt(4)
    v_mfma_f32_32x32x16_bf16 v[160:175], v[100:103], v[148:151], v[160:175]
    ds_read_b64_tr_b16 v[144:145], v16 offset:40960
    ds_read_b64_tr_b16 v[146:147], v16 offset:41472
    v_cvt_pk_bf16_f32 v222, v224, v225
    v_cvt_pk_bf16_f32 v223, v226, v227
    v_cvt_pk_bf16_f32 v224, v228, v229
    v_cvt_pk_bf16_f32 v225, v230, v231
    s_waitcnt lgkmcnt(4)
    v_mfma_f32_32x32x16_bf16 v[160:175], v[104:107], v[152:155], v[160:175]
    ds_read_b64_tr_b16 v[148:149], v16 offset:43008
    ds_read_b64_tr_b16 v[150:151], v16 offset:43520
    v_cvt_pk_bf16_f32 v226, v232, v233
    v_cvt_pk_bf16_f32 v227, v234, v235
    s_mov_b64 vcc, s[56:57]
    s_nop 0
    s_waitcnt lgkmcnt(4)
    v_mfma_f32_32x32x16_bf16 v[160:175], v[108:111], v[156:159], v[160:175]
    ds_read_b64_tr_b16 v[152:153], v16 offset:45056
    ds_read_b64_tr_b16 v[154:155], v16 offset:45568
    v_cndmask_b32_dpp v228, v222, v220, vcc quad_perm:[1,0,3,2] row_mask:0xf bank_mask:0xf
    v_cndmask_b32_dpp v229, v223, v221, vcc quad_perm:[1,0,3,2] row_mask:0xf bank_mask:0xf
    v_cndmask_b32_dpp v232, v226, v224, vcc quad_perm:[1,0,3,2] row_mask:0xf bank_mask:0xf
    v_cndmask_b32_dpp v233, v227, v225, vcc quad_perm:[1,0,3,2] row_mask:0xf bank_mask:0xf
    s_waitcnt lgkmcnt(4)
    v_mfma_f32_32x32x16_bf16 v[160:175], v[112:115], v[144:147], v[160:175]
    ds_read_b64_tr_b16 v[156:157], v16 offset:47104
    ds_read_b64_tr_b16 v[158:159], v16 offset:47616
    s_mov_b64 vcc, s[58:59]
    s_nop 0
    v_cndmask_b32_dpp v230, v220, v222, vcc quad_perm:[1,0,3,2] row_mask:0xf bank_mask:0xf
    v_cndmask_b32_dpp v231, v221, v223, vcc quad_perm:[1,0,3,2] row_mask:0xf bank_mask:0xf
    s_waitcnt lgkmcnt(4)
    v_mfma_f32_32x32x16_bf16 v[160:175], v[116:119], v[148:151], v[160:175]
    ds_read_b64_tr_b16 v[144:145], v16 offset:49152
    ds_read_b64_tr_b16 v[146:147], v16 offset:49664
    v_cndmask_b32_dpp v234, v224, v226, vcc quad_perm:[1,0,3,2] row_mask:0xf bank_mask:0xf
    v_cndmask_b32_dpp v235, v225, v227, vcc quad_perm:[1,0,3,2] row_mask:0xf bank_mask:0xf
    buffer_store_dwordx4 v[228:231], v194, s[24:27], s52 offen sc1
    buffer_store_dwordx4 v[232:235], v195, s[24:27], s52 offen sc1
    s_waitcnt lgkmcnt(4)
    v_mfma_f32_32x32x16_bf16 v[160:175], v[120:123], v[152:155], v[160:175]
    ds_read_b64_tr_b16 v[148:149], v16 offset:51200
    ds_read_b64_tr_b16 v[150:151], v16 offset:51712
    v_cvt_pk_bf16_f32 v236, v236, v237
    v_cvt_pk_bf16_f32 v237, v238, v239
    v_cvt_pk_bf16_f32 v238, v240, v241
    v_cvt_pk_bf16_f32 v239, v242, v243
    s_waitcnt lgkmcnt(4)
    v_mfma_f32_32x32x16_bf16 v[160:175], v[124:127], v[156:159], v[160:175]
    ds_read_b64_tr_b16 v[152:153], v16 offset:53248
    ds_read_b64_tr_b16 v[154:155], v16 offset:53760
    v_cvt_pk_bf16_f32 v240, v244, v245
    v_cvt_pk_bf16_f32 v241, v246, v247
    v_cvt_pk_bf16_f32 v242, v248, v249
    v_cvt_pk_bf16_f32 v243, v250, v251
    s_waitcnt lgkmcnt(4)
    v_mfma_f32_32x32x16_bf16 v[160:175], v[128:131], v[144:147], v[160:175]
    ds_read_b64_tr_b16 v[156:157], v16 offset:55296
    ds_read_b64_tr_b16 v[158:159], v16 offset:55808
    s_mov_b64 vcc, s[56:57]
    s_nop 0
    v_cndmask_b32_dpp v244, v238, v236, vcc quad_perm:[1,0,3,2] row_mask:0xf bank_mask:0xf
    v_cndmask_b32_dpp v245, v239, v237, vcc quad_perm:[1,0,3,2] row_mask:0xf bank_mask:0xf
    s_waitcnt lgkmcnt(4)
    v_mfma_f32_32x32x16_bf16 v[160:175], v[132:135], v[148:151], v[160:175]
    ds_read_b64_tr_b16 v[144:145], v17 offset:0
    ds_read_b64_tr_b16 v[146:147], v17 offset:512
    v_cndmask_b32_dpp v248, v242, v240, vcc quad_perm:[1,0,3,2] row_mask:0xf bank_mask:0xf
    v_cndmask_b32_dpp v249, v243, v241, vcc quad_perm:[1,0,3,2] row_mask:0xf bank_mask:0xf
    s_mov_b64 vcc, s[58:59]
    s_nop 0
    s_waitcnt lgkmcnt(4)
    v_mfma_f32_32x32x16_bf16 v[160:175], v[136:139], v[152:155], v[160:175]
    ds_read_b64_tr_b16 v[148:149], v17 offset:2048
    ds_read_b64_tr_b16 v[150:151], v17 offset:2560
    v_cndmask_b32_dpp v246, v236, v238, vcc quad_perm:[1,0,3,2] row_mask:0xf bank_mask:0xf
    v_cndmask_b32_dpp v247, v237, v239, vcc quad_perm:[1,0,3,2] row_mask:0xf bank_mask:0xf
    v_cndmask_b32_dpp v250, v240, v242, vcc quad_perm:[1,0,3,2] row_mask:0xf bank_mask:0xf
    v_cndmask_b32_dpp v251, v241, v243, vcc quad_perm:[1,0,3,2] row_mask:0xf bank_mask:0xf
    s_waitcnt lgkmcnt(4)
    v_mfma_f32_32x32x16_bf16 v[160:175], v[140:143], v[156:159], v[160:175]
    ds_read_b64_tr_b16 v[152:153], v17 offset:4096
    ds_read_b64_tr_b16 v[154:155], v17 offset:4608
    buffer_store_dwordx4 v[244:247], v196, s[24:27], s54 offen sc1
    buffer_store_dwordx4 v[248:251], v197, s[24:27], s54 offen sc1
    v_cvt_pk_bf16_f32 v176, v176, v177
    v_cvt_pk_bf16_f32 v177, v178, v179
    s_waitcnt lgkmcnt(4)
    v_mfma_f32_32x32x16_bf16 v[204:219], v[32:35], v[144:147], 0
    ds_read_b64_tr_b16 v[156:157], v17 offset:6144
    ds_read_b64_tr_b16 v[158:159], v17 offset:6656
    v_cvt_pk_bf16_f32 v178, v180, v181
    v_cvt_pk_bf16_f32 v179, v182, v183
    v_cvt_pk_bf16_f32 v180, v184, v185
    v_cvt_pk_bf16_f32 v181, v186, v187
    s_waitcnt lgkmcnt(4)
    v_mfma_f32_32x32x16_bf16 v[204:219], v[36:39], v[148:151], v[204:219]
    ds_read_b64_tr_b16 v[144:145], v17 offset:8192
    ds_read_b64_tr_b16 v[146:147], v17 offset:8704
    v_cvt_pk_bf16_f32 v182, v188, v189
    v_cvt_pk_bf16_f32 v183, v190, v191
    s_mov_b64 vcc, s[56:57]
    s_nop 0
    s_waitcnt lgkmcnt(4)
    v_mfma_f32_32x32x16_bf16 v[204:219], v[40:43], v[152:155], v[204:219]
    ds_read_b64_tr_b16 v[148:149], v17 offset:10240
    ds_read_b64_tr_b16 v[150:151], v17 offset:10752
    v_cndmask_b32_dpp v184, v178, v176, vcc quad_perm:[1,0,3,2] row_mask:0xf bank_mask:0xf
    v_cndmask_b32_dpp v185, v179, v177, vcc quad_perm:[1,0,3,2] row_mask:0xf bank_mask:0xf
    v_cndmask_b32_dpp v188, v182, v180, vcc quad_perm:[1,0,3,2] row_mask:0xf bank_mask:0xf
    v_cndmask_b32_dpp v189, v183, v181, vcc quad_perm:[1,0,3,2] row_mask:0xf bank_mask:0xf
    s_waitcnt lgkmcnt(4)
    v_mfma_f32_32x32x16_bf16 v[204:219], v[44:47], v[156:159], v[204:219]
    ds_read_b64_tr_b16 v[152:153], v17 offset:12288
    ds_read_b64_tr_b16 v[154:155], v17 offset:12800
    s_mov_b64 vcc, s[58:59]
    s_nop 0
    v_cndmask_b32_dpp v186, v176, v178, vcc quad_perm:[1,0,3,2] row_mask:0xf bank_mask:0xf
    v_cndmask_b32_dpp v187, v177, v179, vcc quad_perm:[1,0,3,2] row_mask:0xf bank_mask:0xf
    s_waitcnt lgkmcnt(4)
    v_mfma_f32_32x32x16_bf16 v[204:219], v[48:51], v[144:147], v[204:219]
    ds_read_b64_tr_b16 v[156:157], v17 offset:14336
    ds_read_b64_tr_b16 v[158:159], v17 offset:14848
    v_cndmask_b32_dpp v190, v180, v182, vcc quad_perm:[1,0,3,2] row_mask:0xf bank_mask:0xf
    v_cndmask_b32_dpp v191, v181, v183, vcc quad_perm:[1,0,3,2] row_mask:0xf bank_mask:0xf
    buffer_store_dwordx4 v[184:187], v198, s[24:27], s54 offen sc1
    buffer_store_dwordx4 v[188:191], v199, s[24:27], s54 offen sc1
    s_waitcnt lgkmcnt(4)
    v_mfma_f32_32x32x16_bf16 v[204:219], v[52:55], v[148:151], v[204:219]
    ds_read_b64_tr_b16 v[144:145], v17 offset:16384
    ds_read_b64_tr_b16 v[146:147], v17 offset:16896
    v_cvt_pk_bf16_f32 v160, v160, v161
    v_cvt_pk_bf16_f32 v161, v162, v163
    v_cvt_pk_bf16_f32 v162, v164, v165
    v_cvt_pk_bf16_f32 v163, v166, v167
    s_waitcnt lgkmcnt(4)
    v_mfma_f32_32x32x16_bf16 v[204:219], v[56:59], v[152:155], v[204:219]
    ds_read_b64_tr_b16 v[148:149], v17 offset:18432
    ds_read_b64_tr_b16 v[150:151], v17 offset:18944
    v_cvt_pk_bf16_f32 v164, v168, v169
    v_cvt_pk_bf16_f32 v165, v170, v171
    v_cvt_pk_bf16_f32 v166, v172, v173
    v_cvt_pk_bf16_f32 v167, v174, v175
    s_waitcnt lgkmcnt(4)
    v_mfma_f32_32x32x16_bf16 v[204:219], v[60:63], v[156:159], v[204:219]
    ds_read_b64_tr_b16 v[152:153], v17 offset:20480
    ds_read_b64_tr_b16 v[154:155], v17 offset:20992
    buffer_store_dwordx4 v[160:163], v200, s[24:27], s54 offen offset:2048 sc1
    buffer_store_dwordx4 v[164:167], v200, s[24:27], s54 offen offset:3072 sc1
    s_waitcnt lgkmcnt(4)
    v_mfma_f32_32x32x16_bf16 v[204:219], v[64:67], v[144:147], v[204:219]
    ds_read_b64_tr_b16 v[156:157], v17 offset:22528
    ds_read_b64_tr_b16 v[158:159], v17 offset:23040
    s_waitcnt lgkmcnt(4)
    v_mfma_f32_32x32x16_bf16 v[204:219], v[68:71], v[148:151], v[204:219]
    ds_read_b64_tr_b16 v[144:145], v17 offset:24576
    ds_read_b64_tr_b16 v[146:147], v17 offset:25088
    s_waitcnt lgkmcnt(4)
    v_mfma_f32_32x32x16_bf16 v[204:219], v[72:75], v[152:155], v[204:219]
    ds_read_b64_tr_b16 v[148:149], v17 offset:26624
    ds_read_b64_tr_b16 v[150:151], v17 offset:27136
    s_waitcnt lgkmcnt(4)
    v_mfma_f32_32x32x16_bf16 v[204:219], v[76:79], v[156:159], v[204:219]
    ds_read_b64_tr_b16 v[152:153], v17 offset:28672
    ds_read_b64_tr_b16 v[154:155], v17 offset:29184
    s_waitcnt lgkmcnt(4)
    v_mfma_f32_32x32x16_bf16 v[204:219], v[80:83], v[144:147], v[204:219]
    ds_read_b64_tr_b16 v[156:157], v17 offset:30720
    ds_read_b64_tr_b16 v[158:159], v17 offset:31232
    s_waitcnt lgkmcnt(4)
    v_mfma_f32_32x32x16_bf16 v[204:219], v[84:87], v[148:151], v[204:219]
    ds_read_b64_tr_b16 v[144:145], v17 offset:32768
    ds_read_b64_tr_b16 v[146:147], v17 offset:33280
    s_waitcnt lgkmcnt(4)
    v_mfma_f32_32x32x16_bf16 v[204:219], v[88:91], v[152:155], v[204:219]
    ds_read_b64_tr_b16 v[148:149], v17 offset:34816
    ds_read_b64_tr_b16 v[150:151], v17 offset:35328
    s_waitcnt lgkmcnt(4)
    v_mfma_f32_32x32x16_bf16 v[204:219], v[92:95], v[156:159], v[204:219]
    ds_read_b64_tr_b16 v[152:153], v17 offset:36864
    ds_read_b64_tr_b16 v[154:155], v17 offset:37376
    s_waitcnt lgkmcnt(4)
    v_mfma_f32_32x32x16_bf16 v[204:219], v[96:99], v[144:147], v[204:219]
    ds_read_b64_tr_b16 v[156:157], v17 offset:38912
    ds_read_b64_tr_b16 v[158:159], v17 offset:39424
    s_waitcnt lgkmcnt(4)
    v_mfma_f32_32x32x16_bf16 v[204:219], v[100:103], v[148:151], v[204:219]
    ds_read_b64_tr_b16 v[144:145], v17 offset:40960
    ds_read_b64_tr_b16 v[146:147], v17 offset:41472
    s_waitcnt lgkmcnt(4)
    v_mfma_f32_32x32x16_bf16 v[204:219], v[104:107], v[152:155], v[204:219]
    ds_read_b64_tr_b16 v[148:149], v17 offset:43008
    ds_read_b64_tr_b16 v[150:151], v17 offset:43520
    s_waitcnt lgkmcnt(4)
    v_mfma_f32_32x32x16_bf16 v[204:219], v[108:111], v[156:159], v[204:219]
    ds_read_b64_tr_b16 v[152:153], v17 offset:45056
    ds_read_b64_tr_b16 v[154:155], v17 offset:45568
    s_waitcnt lgkmcnt(4)
    v_mfma_f32_32x32x16_bf16 v[204:219], v[112:115], v[144:147], v[204:219]
    ds_read_b64_tr_b16 v[156:157], v17 offset:47104
    ds_read_b64_tr_b16 v[158:159], v17 offset:47616
    s_waitcnt lgkmcnt(4)
    v_mfma_f32_32x32x16_bf16 v[204:219], v[116:119], v[148:151], v[204:219]
    ds_read_b64_tr_b16 v[144:145], v17 offset:49152
    ds_read_b64_tr_b16 v[146:147], v17 offset:49664
    s_waitcnt lgkmcnt(4)
    v_mfma_f32_32x32x16_bf16 v[204:219], v[120:123], v[152:155], v[204:219]
    ds_read_b64_tr_b16 v[148:149], v17 offset:51200
    ds_read_b64_tr_b16 v[150:151], v17 offset:51712
    s_waitcnt lgkmcnt(4)
    v_mfma_f32_32x32x16_bf16 v[204:219], v[124:127], v[156:159], v[204:219]
    ds_read_b64_tr_b16 v[152:153], v17 offset:53248
    ds_read_b64_tr_b16 v[154:155], v17 offset:53760
    s_waitcnt lgkmcnt(4)
    v_mfma_f32_32x32x16_bf16 v[204:219], v[128:131], v[144:147], v[204:219]
    ds_read_b64_tr_b16 v[156:157], v17 offset:55296
    ds_read_b64_tr_b16 v[158:159], v17 offset:55808
    s_waitcnt lgkmcnt(4)
    v_mfma_f32_32x32x16_bf16 v[204:219], v[132:135], v[148:151], v[204:219]
    s_waitcnt lgkmcnt(2)
    v_mfma_f32_32x32x16_bf16 v[204:219], v[136:139], v[152:155], v[204:219]
    s_waitcnt lgkmcnt(0)
    v_mfma_f32_32x32x16_bf16 v[204:219], v[140:143], v[156:159], v[204:219]
    s_nop 7
    s_nop 3
    v_cvt_pk_bf16_f32 v204, v204, v205
    v_cvt_pk_bf16_f32 v205, v206, v207
    v_cvt_pk_bf16_f32 v206, v208, v209
    v_cvt_pk_bf16_f32 v207, v210, v211
    v_cvt_pk_bf16_f32 v208, v212, v213
    v_cvt_pk_bf16_f32 v209, v214, v215
    v_cvt_pk_bf16_f32 v210, v216, v217
    v_cvt_pk_bf16_f32 v211, v218, v219
    buffer_store_dwordx4 v[204:207], v201, s[24:27], s54 offen offset:2048 sc1
    buffer_store_dwordx4 v[208:211], v201, s[24:27], s54 offen offset:3072 sc1
    s_endpgm
L_k1_pads:
    s_sub_u32 s33, s33, 28
    s_lshl_b32 s33, s33, 3
    s_add_u32 s33, s33, s32
    s_lshl_b32 s33, s33, 3
    s_add_u32 s33, s33, s28
    s_lshl_b32 s33, s33, 6
    v_add_u32 v1, s33, v0
    v_mov_b32 v8, 0
    v_mov_b32 v12, 0x3f803f80
    v_mov_b32 v13, 0x00003f80
    v_mov_b32 v14, 0x3f803f80
    v_mov_b32 v15, 0x00003f80
    v_and_b32 v2, 15, v1
    v_lshrrev_b32 v6, 4, v1
    v_lshlrev_b32 v6, 12, v6
    v_lshl_add_u32 v5, v2, 4, v6
    v_add_u32 v5, 1792, v5
    v_and_b32 v2, 3, v1
    v_bfe_u32 v3, v1, 3, 1
    v_and_b32 v4, 7, v1
    v_lshl_add_u32 v6, v3, 10, v6
    v_lshl_add_u32 v6, v4, 4, v6
    v_add_u32 v6, 2944, v6
    v_cmp_eq_u32 vcc, 0, v2
    s_nop 1
    v_cndmask_b32 v16, v8, v12, vcc
    v_cndmask_b32 v17, v8, v12, vcc
    v_cndmask_b32 v18, v8, v12, vcc
    v_cndmask_b32 v19, v8, v12, vcc
    s_waitcnt lgkmcnt(0)
    s_mov_b32 s24, s12
    s_mov_b32 s25, s13
    s_mov_b32 s26, 16777216
    s_mov_b32 s27, 0x00020000
    s_mov_b32 s42, 2097152
    buffer_store_dwordx4 v[12:15], v5, s[24:27], s42 offen sc1
    buffer_store_dwordx4 v[16:19], v6, s[24:27], s42 offen sc1
    s_mov_b32 s42, 8388608
    buffer_store_dwordx4 v[12:15], v5, s[24:27], s42 offen sc1
    buffer_store_dwordx4 v[16:19], v6, s[24:27], s42 offen sc1
    s_cmp_lg_u32 s28, 0
    s_cbranch_scc1 L_k1_nocpf2
    s_getpc_b64 s[44:45]
L_pcb:
    s_add_u32 s44, s44, attn_kernel-L_pcb
    s_addc_u32 s45, s45, (attn_kernel-L_pcb)>>32
    v_lshlrev_b32 v24, 7, v0
    v_add_u32 v24, 0, v24
    v_min_u32 v24, L_k2_end-attn_kernel-4, v24
    v_mov_b32 v25, s45
    v_add_co_u32 v24, vcc, s44, v24
    s_nop 1
    v_addc_co_u32 v25, vcc, 0, v25, vcc
    global_load_dword v26, v[24:25], off
    v_lshlrev_b32 v24, 7, v0
    v_add_u32 v24, 8192, v24
    v_min_u32 v24, L_k2_end-attn_kernel-4, v24
    v_mov_b32 v25, s45
    v_add_co_u32 v24, vcc, s44, v24
    s_nop 1
    v_addc_co_u32 v25, vcc, 0, v25, vcc
    global_load_dword v26, v[24:25], off
L_k1_nocpf2:
    s_mov_b32 s26, 16910336
    s_mov_b32 s42, 16777216
    v_mul_u32_u24 v2, 8320, v1
    buffer_store_dword v8, v2, s[24:27], s42 offen sc1
L_k1_end:
    s_endpgm
.globl attn_kernel
.p2align 8
.type attn_kernel,@function
attn_kernel:
    s_cmp_ge_u32 s2, 256
    s_cbranch_scc1 L_k2_end
    s_load_dwordx2 s[12:13], s[0:1], 64
    s_load_dwordx2 s[4:5], s[0:1], 16
    s_load_dwordx2 s[6:7], s[0:1], 40
    s_load_dwordx2 s[8:9], s[0:1], 48
    v_lshrrev_b32 v1, 6, v0
    v_and_b32 v0, 63, v0
    s_and_b32 s3, s2, 7
    s_lshl_b32 s30, s3, 1
    s_bfe_u32 s3, s2, 0x10003
    s_add_u32 s30, s30, s3
    v_readfirstlane_b32 s28, v1
    s_add_u32 s28, s28, 8
    s_sub_u32 s3, s28, 12
    s_cselect_b32 s28, s28, s3
    s_lshr_b32 s31, s2, 4
    v_lshlrev_b32 v2, 4, v0
    s_mov_b32 s60, 0
    v_mov_b32 v1, 0
    v_mov_b32 v7, 20480
    s_and_b32 s74, s2, 7
    s_lshl_b32 s74, s74, 1
    s_lshr_b32 s75, s2, 7
    s_add_u32 s74, s74, s75
    s_bfe_u32 s75, s2, 0x40003
    s_cmp_ge_u32 s75, 7
    s_cselect_b32 s72, 1, 0
    s_mul_i32 s73, s72, 7
    s_sub_u32 s73, s75, s73
    s_cmp_ge_u32 s28, 8
    s_cbranch_scc1 L_k2_aux
    s_and_b32 s32, s28, 3
    s_lshr_b32 s33, s28, 2
    v_and_b32 v3, 31, v0
    v_lshrrev_b32 v4, 5, v0
    v_lshlrev_b32 v122, 3, v3
    v_lshl_add_u32 v122, v4, 8, v122
    v_bfe_u32 v5, v0, 3, 1
    v_xor_b32 v5, v5, v4
    v_lshlrev_b32 v5, 6, v5
    v_and_b32 v6, 3, v0
    v_lshl_add_u32 v5, v6, 4, v5
    v_lshrrev_b32 v6, 2, v3
    v_lshl_add_u32 v5, v6, 7, v5
    s_lshl_b32 s41, s33, 14
    v_add_u32 v121, s41, v5
    v_add_u32 v123, s41, v122
    v_add_u32 v120, 0x10000, v121
    s_lshl_b32 s41, s32, 11
    s_add_u32 s41, s41, 98304
    v_add_u32 v124, s41, v122
    s_mov_b32 s68, 0
    s_mov_b32 s69, -1
    s_mov_b32 s59, 0xffff0000
    v_mov_b32 v56, 0
    v_mov_b32 v57, 0
    v_mov_b32 v58, 0
    v_mov_b32 v59, 0
    v_mov_b32 v60, 0
    v_mov_b32 v61, 0
    v_mov_b32 v62, 0
    v_mov_b32 v63, 0
    v_mov_b32 v64, 0
    v_mov_b32 v65, 0
    v_mov_b32 v66, 0
    v_mov_b32 v67, 0
    v_mov_b32 v68, 0
    v_mov_b32 v69, 0
    v_mov_b32 v70, 0
    v_mov_b32 v71, 0
    v_mov_b32 v52, 0
    v_mov_b32 v116, 0
    v_mov_b32 v100, 0
    v_mov_b32 v53, 0
    v_mov_b32 v117, 0
    v_mov_b32 v101, 0
    v_mov_b32 v54, 0
    v_mov_b32 v118, 0
    v_mov_b32 v102, 0
    v_mov_b32 v55, 0
    v_mov_b32 v119, 0
    v_mov_b32 v103, 0
    s_waitcnt lgkmcnt(0)
    s_mov_b32 s24, s12
    s_mov_b32 s25, s13
    s_mov_b32 s26, 16910336
    s_mov_b32 s27, 0x00020000
    s_barrier
    ds_read2st64_b64 v[8:11], v124 offset0:0 offset1:1
    ds_read2st64_b64 v[104:107], v122 offset0:0 offset1:1
    ds_read2st64_b64 v[12:15], v124 offset0:2 offset1:3
    ds_read2st64_b64 v[108:111], v122 offset0:2 offset1:3
    s_waitcnt lgkmcnt(2)
    v_mfma_f32_32x32x16_bf16 v[32:47], v[104:107], v[8:11], 0
    ds_read2st64_b64 v[72:75], v123 offset0:0 offset1:1
    ds_read2st64_b64 v[76:79], v123 offset0:2 offset1:3
    s_waitcnt lgkmcnt(2)
    v_cndmask_b32 v14, v14, v1, s[68:69]
    v_cndmask_b32 v15, v15, v1, s[68:69]
    s_nop 1
    v_mfma_f32_32x32x16_bf16 v[32:47], v[108:111], v[12:15], v[32:47]
    s_waitcnt lgkmcnt(0)
    v_mfma_f32_32x32x16_bf16 v[16:31], v[72:75], v[8:11], 0
    v_mfma_f32_32x32x16_bf16 v[16:31], v[76:79], v[12:15], v[16:31]
    ds_read2st64_b64 v[80:83], v123 offset0:8 offset1:9
    ds_read2st64_b64 v[84:87], v123 offset0:10 offset1:11
    ds_read_b128 v[88:91], v121 offset:2048
    ds_read_b128 v[92:95], v121 offset:3072
    s_nop 4
    v_max3_f32 v3, v32, v33, v34
    v_max3_f32 v4, v35, v36, v37
    v_max3_f32 v3, v3, v38, v39
    v_max3_f32 v4, v4, v40, v41
    v_max3_f32 v3, v3, v42, v43
    v_max3_f32 v4, v4, v44, v45
    v_max3_f32 v3, v3, v46, v47
    v_max_f32 v3, v3, v4
    v_mov_b32 v4, v3
    s_nop 1
    v_permlane32_swap_b32 v3, v4
    v_max_f32 v3, v3, v4
    v_add_f32 v3, 0x42c00000, v3
L_k2_setmax:
    v_sub_f32 v6, 0, v3
    v_and_b32 v4, s59, v6
    v_sub_f32 v6, v6, v4
    v_and_b32 v5, s59, v6
    v_sub_f32 v6, v6, v5
    v_lshrrev_b32 v4, 16, v4
    v_or_b32 v4, v4, v5
    v_lshrrev_b32 v6, 16, v6
    v_cndmask_b32 v14, v14, v4, s[68:69]
    v_cndmask_b32 v15, v15, v6, s[68:69]
    v_sub_f32 v16, v16, v3
    v_sub_f32 v17, v17, v3
    v_sub_f32 v18, v18, v3
    v_sub_f32 v19, v19, v3
    v_sub_f32 v20, v20, v3
    v_sub_f32 v21, v21, v3
    v_sub_f32 v22, v22, v3
    v_sub_f32 v23, v23, v3
    v_sub_f32 v24, v24, v3
    v_sub_f32 v25, v25, v3
    v_sub_f32 v26, v26, v3
    v_sub_f32 v27, v27, v3
    v_sub_f32 v28, v28, v3
    v_sub_f32 v29, v29, v3
    v_sub_f32 v30, v30, v3
    v_sub_f32 v31, v31, v3
    s_waitcnt lgkmcnt(0)
    v_mfma_f32_32x32x16_bf16 v[32:47], v[80:83], v[8:11], 0
    ds_read2st64_b64 v[72:75], v123 offset0:16 offset1:17
    ds_read2st64_b64 v[76:79], v123 offset0:18 offset1:19
    v_cvt_pk_bf16_f32 v54, v116, v117
    v_cvt_pk_bf16_f32 v55, v118, v119
    v_exp_f32 v104, v16
    v_exp_f32 v105, v17
    v_exp_f32 v106, v18
    v_exp_f32 v107, v19
    v_mfma_f32_32x32x16_bf16 v[56:71], v[100:103], v[52:55], v[56:71]
    ds_read_b128 v[96:99], v121 offset:6144
    ds_read_b128 v[100:103], v121 offset:7168
    v_cvt_pk_bf16_f32 v48, v104, v105
    v_cvt_pk_bf16_f32 v49, v106, v107
    v_exp_f32 v108, v20
    v_exp_f32 v109, v21
    v_exp_f32 v110, v22
    v_exp_f32 v111, v23
    v_mfma_f32_32x32x16_bf16 v[32:47], v[84:87], v[12:15], v[32:47]
    v_cvt_pk_bf16_f32 v50, v108, v109
    v_cvt_pk_bf16_f32 v51, v110, v111
    v_exp_f32 v112, v24
    v_exp_f32 v113, v25
    v_exp_f32 v114, v26
    v_exp_f32 v115, v27
    v_mfma_f32_32x32x16_bf16 v[56:71], v[88:91], v[48:51], v[56:71]
    v_cvt_pk_bf16_f32 v52, v112, v113
    v_cvt_pk_bf16_f32 v53, v114, v115
    v_exp_f32 v116, v28
    v_exp_f32 v117, v29
    v_exp_f32 v118, v30
    v_exp_f32 v119, v31
    s_waitcnt lgkmcnt(0)
    v_mfma_f32_32x32x16_bf16 v[16:31], v[72:75], v[8:11], 0
    ds_read2st64_b64 v[80:83], v123 offset0:24 offset1:25
    ds_read2st64_b64 v[84:87], v123 offset0:26 offset1:27
    v_cvt_pk_bf16_f32 v54, v116, v117
    v_cvt_pk_bf16_f32 v55, v118, v119
    v_exp_f32 v104, v32
    v_exp_f32 v105, v33
    v_exp_f32 v106, v34
    v_exp_f32 v107, v35
    v_mfma_f32_32x32x16_bf16 v[56:71], v[92:95], v[52:55], v[56:71]
    ds_read_b128 v[88:91], v121 offset:10240
    ds_read_b128 v[92:95], v121 offset:11264
    v_cvt_pk_bf16_f32 v48, v104, v105
    v_cvt_pk_bf16_f32 v49, v106, v107
    v_exp_f32 v108, v36
    v_exp_f32 v109, v37
    v_exp_f32 v110, v38
    v_exp_f32 v111, v39
    v_mfma_f32_32x32x16_bf16 v[16:31], v[76:79], v[12:15], v[16:31]
    v_cvt_pk_bf16_f32 v50, v108, v109
    v_cvt_pk_bf16_f32 v51, v110, v111
    v_exp_f32 v112, v40
    v_exp_f32 v113, v41
    v_exp_f32 v114, v42
    v_exp_f32 v115, v43
    v_mfma_f32_32x32x16_bf16 v[56:71], v[96:99], v[48:51], v[56:71]
    v_cvt_pk_bf16_f32 v52, v112, v113
    v_cvt_pk_bf16_f32 v53, v114, v115
    v_exp_f32 v116, v44
    v_exp_f32 v117, v45
    v_exp_f32 v118, v46
    v_exp_f32 v119, v47
    s_waitcnt lgkmcnt(0)
    s_barrier
    v_mfma_f32_32x32x16_bf16 v[32:47], v[80:83], v[8:11], 0
    ds_read2st64_b64 v[72:75], v123 offset0:64 offset1:65
    ds_read2st64_b64 v[76:79], v123 offset0:66 offset1:67
    v_cvt_pk_bf16_f32 v54, v116, v117
    v_cvt_pk_bf16_f32 v55, v118, v119
    v_exp_f32 v104, v16
    v_exp_f32 v105, v17
    v_exp_f32 v106, v18
    v_exp_f32 v107, v19
    v_mfma_f32_32x32x16_bf16 v[56:71], v[100:103], v[52:55], v[56:71]
    ds_read_b128 v[96:99], v121 offset:14336
    ds_read_b128 v[100:103], v121 offset:15360
    v_cvt_pk_bf16_f32 v48, v104, v105
    v_cvt_pk_bf16_f32 v49, v106, v107
    v_exp_f32 v108, v20
    v_exp_f32 v109, v21
    v_exp_f32 v110, v22
    v_exp_f32 v111, v23
    v_mfma_f32_32x32x16_bf16 v[32:47], v[84:87], v[12:15], v[32:47]
    v_cvt_pk_bf16_f32 v50, v108, v109
    v_cvt_pk_bf16_f32 v51, v110, v111
    v_exp_f32 v112, v24
    v_exp_f32 v113, v25
    v_exp_f32 v114, v26
    v_exp_f32 v115, v27
    v_mfma_f32_32x32x16_bf16 v[56:71], v[88:91], v[48:51], v[56:71]
    v_cvt_pk_bf16_f32 v52, v112, v113
    v_cvt_pk_bf16_f32 v53, v114, v115
    v_exp_f32 v116, v28
    v_exp_f32 v117, v29
    v_exp_f32 v118, v30
    v_exp_f32 v119, v31
    s_waitcnt lgkmcnt(0)
    v_mfma_f32_32x32x16_bf16 v[16:31], v[72:75], v[8:11], 0
    ds_read2st64_b64 v[80:83], v123 offset0:72 offset1:73
    ds_read2st64_b64 v[84:87], v123 offset0:74 offset1:75
    v_cvt_pk_bf16_f32 v54, v116, v117
    v_cvt_pk_bf16_f32 v55, v118, v119
    v_exp_f32 v104, v32
    v_exp_f32 v105, v33
    v_exp_f32 v106, v34
    v_exp_f32 v107, v35
    v_mfma_f32_32x32x16_bf16 v[56:71], v[92:95], v[52:55], v[56:71]
    ds_read_b128 v[88:91], v121 offset:34816
    ds_read_b128 v[92:95], v121 offset:35840
    v_cvt_pk_bf16_f32 v48, v104, v105
    v_cvt_pk_bf16_f32 v49, v106, v107
    v_exp_f32 v108, v36
    v_exp_f32 v109, v37
    v_exp_f32 v110, v38
    v_exp_f32 v111, v39
    v_mfma_f32_32x32x16_bf16 v[16:31], v[76:79], v[12:15], v[16:31]
    v_cvt_pk_bf16_f32 v50, v108, v109
    v_cvt_pk_bf16_f32 v51, v110, v111
    v_exp_f32 v112, v40
    v_exp_f32 v113, v41
    v_exp_f32 v114, v42
    v_exp_f32 v115, v43
    v_mfma_f32_32x32x16_bf16 v[56:71], v[96:99], v[48:51], v[56:71]
    v_cvt_pk_bf16_f32 v52, v112, v113
    v_cvt_pk_bf16_f32 v53, v114, v115
    v_exp_f32 v116, v44
    v_exp_f32 v117, v45
    v_exp_f32 v118, v46
    v_exp_f32 v119, v47
    s_waitcnt lgkmcnt(0)
    v_mfma_f32_32x32x16_bf16 v[32:47], v[80:83], v[8:11], 0
    ds_read2st64_b64 v[72:75], v123 offset0:80 offset1:81
    ds_read2st64_b64 v[76:79], v123 offset0:82 offset1:83
    v_cvt_pk_bf16_f32 v54, v116, v117
    v_cvt_pk_bf16_f32 v55, v118, v119
    v_exp_f32 v104, v16
    v_exp_f32 v105, v17
    v_exp_f32 v106, v18
    v_exp_f32 v107, v19
    v_mfma_f32_32x32x16_bf16 v[56:71], v[100:103], v[52:55], v[56:71]
    ds_read_b128 v[96:99], v121 offset:38912
    ds_read_b128 v[100:103], v121 offset:39936
    v_cvt_pk_bf16_f32 v48, v104, v105
    v_cvt_pk_bf16_f32 v49, v106, v107
    v_exp_f32 v108, v20
    v_exp_f32 v109, v21
    v_exp_f32 v110, v22
    v_exp_f32 v111, v23
    v_mfma_f32_32x32x16_bf16 v[32:47], v[84:87], v[12:15], v[32:47]
    v_cvt_pk_bf16_f32 v50, v108, v109
    v_cvt_pk_bf16_f32 v51, v110, v111
    v_exp_f32 v112, v24
    v_exp_f32 v113, v25
    v_exp_f32 v114, v26
    v_exp_f32 v115, v27
    v_mfma_f32_32x32x16_bf16 v[56:71], v[88:91], v[48:51], v[56:71]
    v_cvt_pk_bf16_f32 v52, v112, v113
    v_cvt_pk_bf16_f32 v53, v114, v115
    v_exp_f32 v116, v28
    v_exp_f32 v117, v29
    v_exp_f32 v118, v30
    v_exp_f32 v119, v31
    s_waitcnt lgkmcnt(0)
    v_mfma_f32_32x32x16_bf16 v[16:31], v[72:75], v[8:11], 0
    ds_read2st64_b64 v[80:83], v123 offset0:88 offset1:89
    ds_read2st64_b64 v[84:87], v123 offset0:90 offset1:91
    v_cvt_pk_bf16_f32 v54, v116, v117
    v_cvt_pk_bf16_f32 v55, v118, v119
    v_exp_f32 v104, v32
    v_exp_f32 v105, v33
    v_exp_f32 v106, v34
    v_exp_f32 v107, v35
    v_mfma_f32_32x32x16_bf16 v[56:71], v[92:95], v[52:55], v[56:71]
    ds_read_b128 v[88:91], v121 offset:43008
    ds_read_b128 v[92:95], v121 offset:44032
    v_cvt_pk_bf16_f32 v48, v104, v105
    v_cvt_pk_bf16_f32 v49, v106, v107
    v_exp_f32 v108, v36
    v_exp_f32 v109, v37
    v_exp_f32 v110, v38
    v_exp_f32 v111, v39
    v_mfma_f32_32x32x16_bf16 v[16:31], v[76:79], v[12:15], v[16:31]
    v_cvt_pk_bf16_f32 v50, v108, v109
    v_cvt_pk_bf16_f32 v51, v110, v111
    v_exp_f32 v112, v40
    v_exp_f32 v113, v41
    v_exp_f32 v114, v42
    v_exp_f32 v115, v43
    v_mfma_f32_32x32x16_bf16 v[56:71], v[96:99], v[48:51], v[56:71]
    v_cvt_pk_bf16_f32 v52, v112, v113
    v_cvt_pk_bf16_f32 v53, v114, v115
    v_exp_f32 v116, v44
    v_exp_f32 v117, v45
    v_exp_f32 v118, v46
    v_exp_f32 v119, v47
    s_waitcnt lgkmcnt(0)
    s_barrier
    v_mfma_f32_32x32x16_bf16 v[32:47], v[80:83], v[8:11], 0
    ds_read2st64_b64 v[72:75], v123 offset0:128 offset1:129
    ds_read2st64_b64 v[76:79], v123 offset0:130 offset1:131
    v_cvt_pk_bf16_f32 v54, v116, v117
    v_cvt_pk_bf16_f32 v55, v118, v119
    v_exp_f32 v104, v16
    v_exp_f32 v105, v17
    v_exp_f32 v106, v18
    v_exp_f32 v107, v19
    v_mfma_f32_32x32x16_bf16 v[56:71], v[100:103], v[52:55], v[56:71]
    ds_read_b128 v[96:99], v121 offset:47104
    ds_read_b128 v[100:103], v121 offset:48128
    v_cvt_pk_bf16_f32 v48, v104, v105
    v_cvt_pk_bf16_f32 v49, v106, v107
    v_exp_f32 v108, v20
    v_exp_f32 v109, v21
    v_exp_f32 v110, v22
    v_exp_f32 v111, v23
    v_mfma_f32_32x32x16_bf16 v[32:47], v[84:87], v[12:15], v[32:47]
    v_cvt_pk_bf16_f32 v50, v108, v109
    v_cvt_pk_bf16_f32 v51, v110, v111
    v_exp_f32 v112, v24
    v_exp_f32 v113, v25
    v_exp_f32 v114, v26
    v_exp_f32 v115, v27
    v_mfma_f32_32x32x16_bf16 v[56:71], v[88:91], v[48:51], v[56:71]
    v_cvt_pk_bf16_f32 v52, v112, v113
    v_cvt_pk_bf16_f32 v53, v114, v115
    v_exp_f32 v116, v28
    v_exp_f32 v117, v29
    v_exp_f32 v118, v30
    v_exp_f32 v119, v31
    s_waitcnt lgkmcnt(0)
    v_mfma_f32_32x32x16_bf16 v[16:31], v[72:75], v[8:11], 0
    ds_read2st64_b64 v[80:83], v123 offset0:136 offset1:137
    ds_read2st64_b64 v[84:87], v123 offset0:138 offset1:139
    v_cvt_pk_bf16_f32 v54, v116, v117
    v_cvt_pk_bf16_f32 v55, v118, v119
    v_exp_f32 v104, v32
    v_exp_f32 v105, v33
    v_exp_f32 v106, v34
    v_exp_f32 v107, v35
    v_mfma_f32_32x32x16_bf16 v[56:71], v[92:95], v[52:55], v[56:71]
    ds_read_b128 v[88:91], v120 offset:2048
    ds_read_b128 v[92:95], v120 offset:3072
    v_cvt_pk_bf16_f32 v48, v104, v105
    v_cvt_pk_bf16_f32 v49, v106, v107
    v_exp_f32 v108, v36
    v_exp_f32 v109, v37
    v_exp_f32 v110, v38
    v_exp_f32 v111, v39
    v_mfma_f32_32x32x16_bf16 v[16:31], v[76:79], v[12:15], v[16:31]
    v_cvt_pk_bf16_f32 v50, v108, v109
    v_cvt_pk_bf16_f32 v51, v110, v111
    v_exp_f32 v112, v40
    v_exp_f32 v113, v41
    v_exp_f32 v114, v42
    v_exp_f32 v115, v43
    v_mfma_f32_32x32x16_bf16 v[56:71], v[96:99], v[48:51], v[56:71]
    v_cvt_pk_bf16_f32 v52, v112, v113
    v_cvt_pk_bf16_f32 v53, v114, v115
    v_exp_f32 v116, v44
    v_exp_f32 v117, v45
    v_exp_f32 v118, v46
    v_exp_f32 v119, v47
    s_waitcnt lgkmcnt(0)
    v_mfma_f32_32x32x16_bf16 v[32:47], v[80:83], v[8:11], 0
    ds_read2st64_b64 v[72:75], v123 offset0:144 offset1:145
    ds_read2st64_b64 v[76:79], v123 offset0:146 offset1:147
    v_cvt_pk_bf16_f32 v54, v116, v117
    v_cvt_pk_bf16_f32 v55, v118, v119
    v_exp_f32 v104, v16
    v_exp_f32 v105, v17
    v_exp_f32 v106, v18
    v_exp_f32 v107, v19
    v_mfma_f32_32x32x16_bf16 v[56:71], v[100:103], v[52:55], v[56:71]
    ds_read_b128 v[96:99], v120 offset:6144
    ds_read_b128 v[100:103], v120 offset:7168
    v_cvt_pk_bf16_f32 v48, v104, v105
    v_cvt_pk_bf16_f32 v49, v106, v107
    v_exp_f32 v108, v20
    v_exp_f32 v109, v21
    v_exp_f32 v110, v22
    v_exp_f32 v111, v23
    v_mfma_f32_32x32x16_bf16 v[32:47], v[84:87], v[12:15], v[32:47]
    v_cvt_pk_bf16_f32 v50, v108, v109
    v_cvt_pk_bf16_f32 v51, v110, v111
    v_exp_f32 v112, v24
    v_exp_f32 v113, v25
    v_exp_f32 v114, v26
    v_exp_f32 v115, v27
    v_mfma_f32_32x32x16_bf16 v[56:71], v[88:91], v[48:51], v[56:71]
    v_cvt_pk_bf16_f32 v52, v112, v113
    v_cvt_pk_bf16_f32 v53, v114, v115
    v_exp_f32 v116, v28
    v_exp_f32 v117, v29
    v_exp_f32 v118, v30
    v_exp_f32 v119, v31
    s_waitcnt lgkmcnt(0)
    v_mfma_f32_32x32x16_bf16 v[16:31], v[72:75], v[8:11], 0
    ds_read2st64_b64 v[80:83], v123 offset0:152 offset1:153
    ds_read2st64_b64 v[84:87], v123 offset0:154 offset1:155
    v_cvt_pk_bf16_f32 v54, v116, v117
    v_cvt_pk_bf16_f32 v55, v118, v119
    v_exp_f32 v104, v32
    v_exp_f32 v105, v33
    v_exp_f32 v106, v34
    v_exp_f32 v107, v35
    v_mfma_f32_32x32x16_bf16 v[56:71], v[92:95], v[52:55], v[56:71]
    ds_read_b128 v[88:91], v120 offset:10240
    ds_read_b128 v[92:95], v120 offset:11264
    v_cvt_pk_bf16_f32 v48, v104, v105
    v_cvt_pk_bf16_f32 v49, v106, v107
    v_exp_f32 v108, v36
    v_exp_f32 v109, v37
    v_exp_f32 v110, v38
    v_exp_f32 v111, v39
    v_mfma_f32_32x32x16_bf16 v[16:31], v[76:79], v[12:15], v[16:31]
    v_cvt_pk_bf16_f32 v50, v108, v109
    v_cvt_pk_bf16_f32 v51, v110, v111
    v_exp_f32 v112, v40
    v_exp_f32 v113, v41
    v_exp_f32 v114, v42
    v_exp_f32 v115, v43
    v_mfma_f32_32x32x16_bf16 v[56:71], v[96:99], v[48:51], v[56:71]
    v_cvt_pk_bf16_f32 v52, v112, v113
    v_cvt_pk_bf16_f32 v53, v114, v115
    v_exp_f32 v116, v44
    v_exp_f32 v117, v45
    v_exp_f32 v118, v46
    v_exp_f32 v119, v47
    s_waitcnt lgkmcnt(0)
    s_barrier
    v_mfma_f32_32x32x16_bf16 v[32:47], v[80:83], v[8:11], 0
    ds_read2st64_b64 v[72:75], v123 offset0:192 offset1:193
    ds_read2st64_b64 v[76:79], v123 offset0:194 offset1:195
    v_cvt_pk_bf16_f32 v54, v116, v117
    v_cvt_pk_bf16_f32 v55, v118, v119
    v_exp_f32 v104, v16
    v_exp_f32 v105, v17
    v_exp_f32 v106, v18
    v_exp_f32 v107, v19
    v_mfma_f32_32x32x16_bf16 v[56:71], v[100:103], v[52:55], v[56:71]
    ds_read_b128 v[96:99], v120 offset:14336
    ds_read_b128 v[100:103], v120 offset:15360
    v_cvt_pk_bf16_f32 v48, v104, v105
    v_cvt_pk_bf16_f32 v49, v106, v107
    v_exp_f32 v108, v20
    v_exp_f32 v109, v21
    v_exp_f32 v110, v22
    v_exp_f32 v111, v23
    v_mfma_f32_32x32x16_bf16 v[32:47], v[84:87], v[12:15], v[32:47]
    v_cvt_pk_bf16_f32 v50, v108, v109
    v_cvt_pk_bf16_f32 v51, v110, v111
    v_exp_f32 v112, v24
    v_exp_f32 v113, v25
    v_exp_f32 v114, v26
    v_exp_f32 v115, v27
    v_mfma_f32_32x32x16_bf16 v[56:71], v[88:91], v[48:51], v[56:71]
    v_cvt_pk_bf16_f32 v52, v112, v113
    v_cvt_pk_bf16_f32 v53, v114, v115
    v_exp_f32 v116, v28
    v_exp_f32 v117, v29
    v_exp_f32 v118, v30
    v_exp_f32 v119, v31
    s_waitcnt lgkmcnt(0)
    v_mfma_f32_32x32x16_bf16 v[16:31], v[72:75], v[8:11], 0
    ds_read2st64_b64 v[80:83], v123 offset0:200 offset1:201
    ds_read2st64_b64 v[84:87], v123 offset0:202 offset1:203
    v_cvt_pk_bf16_f32 v54, v116, v117
    v_cvt_pk_bf16_f32 v55, v118, v119
    v_exp_f32 v104, v32
    v_exp_f32 v105, v33
    v_exp_f32 v106, v34
    v_exp_f32 v107, v35
    v_mfma_f32_32x32x16_bf16 v[56:71], v[92:95], v[52:55], v[56:71]
    ds_read_b128 v[88:91], v120 offset:34816
    ds_read_b128 v[92:95], v120 offset:35840
    v_cvt_pk_bf16_f32 v48, v104, v105
    v_cvt_pk_bf16_f32 v49, v106, v107
    v_exp_f32 v108, v36
    v_exp_f32 v109, v37
    v_exp_f32 v110, v38
    v_exp_f32 v111, v39
    v_mfma_f32_32x32x16_bf16 v[16:31], v[76:79], v[12:15], v[16:31]
    v_cvt_pk_bf16_f32 v50, v108, v109
    v_cvt_pk_bf16_f32 v51, v110, v111
    v_exp_f32 v112, v40
    v_exp_f32 v113, v41
    v_exp_f32 v114, v42
    v_exp_f32 v115, v43
    v_mfma_f32_32x32x16_bf16 v[56:71], v[96:99], v[48:51], v[56:71]
    v_cvt_pk_bf16_f32 v52, v112, v113
    v_cvt_pk_bf16_f32 v53, v114, v115
    v_exp_f32 v116, v44
    v_exp_f32 v117, v45
    v_exp_f32 v118, v46
    v_exp_f32 v119, v47
    s_waitcnt lgkmcnt(0)
    v_mfma_f32_32x32x16_bf16 v[32:47], v[80:83], v[8:11], 0
    ds_read2st64_b64 v[72:75], v123 offset0:208 offset1:209
    ds_read2st64_b64 v[76:79], v123 offset0:210 offset1:211
    v_cvt_pk_bf16_f32 v54, v116, v117
    v_cvt_pk_bf16_f32 v55, v118, v119
    v_exp_f32 v104, v16
    v_exp_f32 v105, v17
    v_exp_f32 v106, v18
    v_exp_f32 v107, v19
    v_mfma_f32_32x32x16_bf16 v[56:71], v[100:103], v[52:55], v[56:71]
    ds_read_b128 v[96:99], v120 offset:38912
    ds_read_b128 v[100:103], v120 offset:39936
    v_cvt_pk_bf16_f32 v48, v104, v105
    v_cvt_pk_bf16_f32 v49, v106, v107
    v_exp_f32 v108, v20
    v_exp_f32 v109, v21
    v_exp_f32 v110, v22
    v_exp_f32 v111, v23
    v_mfma_f32_32x32x16_bf16 v[32:47], v[84:87], v[12:15], v[32:47]
    v_cvt_pk_bf16_f32 v50, v108, v109
    v_cvt_pk_bf16_f32 v51, v110, v111
    v_exp_f32 v112, v24
    v_exp_f32 v113, v25
    v_exp_f32 v114, v26
    v_exp_f32 v115, v27
    v_mfma_f32_32x32x16_bf16 v[56:71], v[88:91], v[48:51], v[56:71]
    v_cvt_pk_bf16_f32 v52, v112, v113
    v_cvt_pk_bf16_f32 v53, v114, v115
    v_exp_f32 v116, v28
    v_exp_f32 v117, v29
    v_exp_f32 v118, v30
    v_exp_f32 v119, v31
    s_waitcnt lgkmcnt(0)
    v_mfma_f32_32x32x16_bf16 v[16:31], v[72:75], v[8:11], 0
    ds_read2st64_b64 v[80:83], v123 offset0:216 offset1:217
    ds_read2st64_b64 v[84:87], v123 offset0:218 offset1:219
    v_cvt_pk_bf16_f32 v54, v116, v117
    v_cvt_pk_bf16_f32 v55, v118, v119
    v_exp_f32 v104, v32
    v_exp_f32 v105, v33
    v_exp_f32 v106, v34
    v_exp_f32 v107, v35
    v_mfma_f32_32x32x16_bf16 v[56:71], v[92:95], v[52:55], v[56:71]
    ds_read_b128 v[88:91], v120 offset:43008
    ds_read_b128 v[92:95], v120 offset:44032
    v_cvt_pk_bf16_f32 v48, v104, v105
    v_cvt_pk_bf16_f32 v49, v106, v107
    v_exp_f32 v108, v36
    v_exp_f32 v109, v37
    v_exp_f32 v110, v38
    v_exp_f32 v111, v39
    v_mfma_f32_32x32x16_bf16 v[16:31], v[76:79], v[12:15], v[16:31]
    v_cvt_pk_bf16_f32 v50, v108, v109
    v_cvt_pk_bf16_f32 v51, v110, v111
    v_exp_f32 v112, v40
    v_exp_f32 v113, v41
    v_exp_f32 v114, v42
    v_exp_f32 v115, v43
    v_mfma_f32_32x32x16_bf16 v[56:71], v[96:99], v[48:51], v[56:71]
    v_cvt_pk_bf16_f32 v52, v112, v113
    v_cvt_pk_bf16_f32 v53, v114, v115
    v_exp_f32 v116, v44
    v_exp_f32 v117, v45
    v_exp_f32 v118, v46
    v_exp_f32 v119, v47
    s_waitcnt lgkmcnt(0)
    s_barrier
    v_mfma_f32_32x32x16_bf16 v[32:47], v[80:83], v[8:11], 0
    ds_read2st64_b64 v[72:75], v123 offset0:0 offset1:1
    ds_read2st64_b64 v[76:79], v123 offset0:2 offset1:3
    v_cvt_pk_bf16_f32 v54, v116, v117
    v_cvt_pk_bf16_f32 v55, v118, v119
    v_exp_f32 v104, v16
    v_exp_f32 v105, v17
    v_exp_f32 v106, v18
    v_exp_f32 v107, v19
    v_mfma_f32_32x32x16_bf16 v[56:71], v[100:103], v[52:55], v[56:71]
    ds_read_b128 v[96:99], v120 offset:47104
    ds_read_b128 v[100:103], v120 offset:48128
    v_cvt_pk_bf16_f32 v48, v104, v105
    v_cvt_pk_bf16_f32 v49, v106, v107
    v_exp_f32 v108, v20
    v_exp_f32 v109, v21
    v_exp_f32 v110, v22
    v_exp_f32 v111, v23
    v_mfma_f32_32x32x16_bf16 v[32:47], v[84:87], v[12:15], v[32:47]
    v_cvt_pk_bf16_f32 v50, v108, v109
    v_cvt_pk_bf16_f32 v51, v110, v111
    v_exp_f32 v112, v24
    v_exp_f32 v113, v25
    v_exp_f32 v114, v26
    v_exp_f32 v115, v27
    v_mfma_f32_32x32x16_bf16 v[56:71], v[88:91], v[48:51], v[56:71]
    v_cvt_pk_bf16_f32 v52, v112, v113
    v_cvt_pk_bf16_f32 v53, v114, v115
    v_exp_f32 v116, v28
    v_exp_f32 v117, v29
    v_exp_f32 v118, v30
    v_exp_f32 v119, v31
    s_waitcnt lgkmcnt(0)
    v_mfma_f32_32x32x16_bf16 v[16:31], v[72:75], v[8:11], 0
    ds_read2st64_b64 v[80:83], v123 offset0:8 offset1:9
    ds_read2st64_b64 v[84:87], v123 offset0:10 offset1:11
    v_cvt_pk_bf16_f32 v54, v116, v117
    v_cvt_pk_bf16_f32 v55, v118, v119
    v_exp_f32 v104, v32
    v_exp_f32 v105, v33
    v_exp_f32 v106, v34
    v_exp_f32 v107, v35
    v_mfma_f32_32x32x16_bf16 v[56:71], v[92:95], v[52:55], v[56:71]
    ds_read_b128 v[88:91], v121 offset:2048
    ds_read_b128 v[92:95], v121 offset:3072
    v_cvt_pk_bf16_f32 v48, v104, v105
    v_cvt_pk_bf16_f32 v49, v106, v107
    v_exp_f32 v108, v36
    v_exp_f32 v109, v37
    v_exp_f32 v110, v38
    v_exp_f32 v111, v39
    v_mfma_f32_32x32x16_bf16 v[16:31], v[76:79], v[12:15], v[16:31]
    v_cvt_pk_bf16_f32 v50, v108, v109
    v_cvt_pk_bf16_f32 v51, v110, v111
    v_exp_f32 v112, v40
    v_exp_f32 v113, v41
    v_exp_f32 v114, v42
    v_exp_f32 v115, v43
    v_mfma_f32_32x32x16_bf16 v[56:71], v[96:99], v[48:51], v[56:71]
    v_cvt_pk_bf16_f32 v52, v112, v113
    v_cvt_pk_bf16_f32 v53, v114, v115
    v_exp_f32 v116, v44
    v_exp_f32 v117, v45
    v_exp_f32 v118, v46
    v_exp_f32 v119, v47
    s_waitcnt lgkmcnt(0)
    v_mfma_f32_32x32x16_bf16 v[32:47], v[80:83], v[8:11], 0
    ds_read2st64_b64 v[72:75], v123 offset0:16 offset1:17
    ds_read2st64_b64 v[76:79], v123 offset0:18 offset1:19
    v_cvt_pk_bf16_f32 v54, v116, v117
    v_cvt_pk_bf16_f32 v55, v118, v119
    v_exp_f32 v104, v16
    v_exp_f32 v105, v17
    v_exp_f32 v106, v18
    v_exp_f32 v107, v19
    v_mfma_f32_32x32x16_bf16 v[56:71], v[100:103], v[52:55], v[56:71]
    ds_read_b128 v[96:99], v121 offset:6144
    ds_read_b128 v[100:103], v121 offset:7168
    v_cvt_pk_bf16_f32 v48, v104, v105
    v_cvt_pk_bf16_f32 v49, v106, v107
    v_exp_f32 v108, v20
    v_exp_f32 v109, v21
    v_exp_f32 v110, v22
    v_exp_f32 v111, v23
    v_mfma_f32_32x32x16_bf16 v[32:47], v[84:87], v[12:15], v[32:47]
    v_cvt_pk_bf16_f32 v50, v108, v109
    v_cvt_pk_bf16_f32 v51, v110, v111
    v_exp_f32 v112, v24
    v_exp_f32 v113, v25
    v_exp_f32 v114, v26
    v_exp_f32 v115, v27
    v_mfma_f32_32x32x16_bf16 v[56:71], v[88:91], v[48:51], v[56:71]
    v_cvt_pk_bf16_f32 v52, v112, v113
    v_cvt_pk_bf16_f32 v53, v114, v115
    v_exp_f32 v116, v28
    v_exp_f32 v117, v29
    v_exp_f32 v118, v30
    v_exp_f32 v119, v31
    s_waitcnt lgkmcnt(0)
    v_mfma_f32_32x32x16_bf16 v[16:31], v[72:75], v[8:11], 0
    ds_read2st64_b64 v[80:83], v123 offset0:24 offset1:25
    ds_read2st64_b64 v[84:87], v123 offset0:26 offset1:27
    v_cvt_pk_bf16_f32 v54, v116, v117
    v_cvt_pk_bf16_f32 v55, v118, v119
    v_exp_f32 v104, v32
    v_exp_f32 v105, v33
    v_exp_f32 v106, v34
    v_exp_f32 v107, v35
    v_mfma_f32_32x32x16_bf16 v[56:71], v[92:95], v[52:55], v[56:71]
    ds_read_b128 v[88:91], v121 offset:10240
    ds_read_b128 v[92:95], v121 offset:11264
    v_cvt_pk_bf16_f32 v48, v104, v105
    v_cvt_pk_bf16_f32 v49, v106, v107
    v_exp_f32 v108, v36
    v_exp_f32 v109, v37
    v_exp_f32 v110, v38
    v_exp_f32 v111, v39
    v_mfma_f32_32x32x16_bf16 v[16:31], v[76:79], v[12:15], v[16:31]
    v_cvt_pk_bf16_f32 v50, v108, v109
    v_cvt_pk_bf16_f32 v51, v110, v111
    v_exp_f32 v112, v40
    v_exp_f32 v113, v41
    v_exp_f32 v114, v42
    v_exp_f32 v115, v43
    v_mfma_f32_32x32x16_bf16 v[56:71], v[96:99], v[48:51], v[56:71]
    v_cvt_pk_bf16_f32 v52, v112, v113
    v_cvt_pk_bf16_f32 v53, v114, v115
    v_exp_f32 v116, v44
    v_exp_f32 v117, v45
    v_exp_f32 v118, v46
    v_exp_f32 v119, v47
    s_waitcnt lgkmcnt(0)
    s_barrier
    v_mfma_f32_32x32x16_bf16 v[32:47], v[80:83], v[8:11], 0
    ds_read2st64_b64 v[72:75], v123 offset0:64 offset1:65
    ds_read2st64_b64 v[76:79], v123 offset0:66 offset1:67
    v_cvt_pk_bf16_f32 v54, v116, v117
    v_cvt_pk_bf16_f32 v55, v118, v119
    v_exp_f32 v104, v16
    v_exp_f32 v105, v17
    v_exp_f32 v106, v18
    v_exp_f32 v107, v19
    v_mfma_f32_32x32x16_bf16 v[56:71], v[100:103], v[52:55], v[56:71]
    ds_read_b128 v[96:99], v121 offset:14336
    ds_read_b128 v[100:103], v121 offset:15360
    v_cvt_pk_bf16_f32 v48, v104, v105
    v_cvt_pk_bf16_f32 v49, v106, v107
    v_exp_f32 v108, v20
    v_exp_f32 v109, v21
    v_exp_f32 v110, v22
    v_exp_f32 v111, v23
    v_mfma_f32_32x32x16_bf16 v[32:47], v[84:87], v[12:15], v[32:47]
    v_cvt_pk_bf16_f32 v50, v108, v109
    v_cvt_pk_bf16_f32 v51, v110, v111
    v_exp_f32 v112, v24
    v_exp_f32 v113, v25
    v_exp_f32 v114, v26
    v_exp_f32 v115, v27
    v_mfma_f32_32x32x16_bf16 v[56:71], v[88:91], v[48:51], v[56:71]
    v_cvt_pk_bf16_f32 v52, v112, v113
    v_cvt_pk_bf16_f32 v53, v114, v115
    v_exp_f32 v116, v28
    v_exp_f32 v117, v29
    v_exp_f32 v118, v30
    v_exp_f32 v119, v31
    s_waitcnt lgkmcnt(0)
    v_mfma_f32_32x32x16_bf16 v[16:31], v[72:75], v[8:11], 0
    ds_read2st64_b64 v[80:83], v123 offset0:72 offset1:73
    ds_read2st64_b64 v[84:87], v123 offset0:74 offset1:75
    v_cvt_pk_bf16_f32 v54, v116, v117
    v_cvt_pk_bf16_f32 v55, v118, v119
    v_exp_f32 v104, v32
    v_exp_f32 v105, v33
    v_exp_f32 v106, v34
    v_exp_f32 v107, v35
    v_mfma_f32_32x32x16_bf16 v[56:71], v[92:95], v[52:55], v[56:71]
    ds_read_b128 v[88:91], v121 offset:34816
    ds_read_b128 v[92:95], v121 offset:35840
    v_cvt_pk_bf16_f32 v48, v104, v105
    v_cvt_pk_bf16_f32 v49, v106, v107
    v_exp_f32 v108, v36
    v_exp_f32 v109, v37
    v_exp_f32 v110, v38
    v_exp_f32 v111, v39
    v_mfma_f32_32x32x16_bf16 v[16:31], v[76:79], v[12:15], v[16:31]
    v_cvt_pk_bf16_f32 v50, v108, v109
    v_cvt_pk_bf16_f32 v51, v110, v111
    v_exp_f32 v112, v40
    v_exp_f32 v113, v41
    v_exp_f32 v114, v42
    v_exp_f32 v115, v43
    v_mfma_f32_32x32x16_bf16 v[56:71], v[96:99], v[48:51], v[56:71]
    v_cvt_pk_bf16_f32 v52, v112, v113
    v_cvt_pk_bf16_f32 v53, v114, v115
    v_exp_f32 v116, v44
    v_exp_f32 v117, v45
    v_exp_f32 v118, v46
    v_exp_f32 v119, v47
    s_waitcnt lgkmcnt(0)
    v_mfma_f32_32x32x16_bf16 v[32:47], v[80:83], v[8:11], 0
    ds_read2st64_b64 v[72:75], v123 offset0:80 offset1:81
    ds_read2st64_b64 v[76:79], v123 offset0:82 offset1:83
    v_cvt_pk_bf16_f32 v54, v116, v117
    v_cvt_pk_bf16_f32 v55, v118, v119
    v_exp_f32 v104, v16
    v_exp_f32 v105, v17
    v_exp_f32 v106, v18
    v_exp_f32 v107, v19
    v_mfma_f32_32x32x16_bf16 v[56:71], v[100:103], v[52:55], v[56:71]
    ds_read_b128 v[96:99], v121 offset:38912
    ds_read_b128 v[100:103], v121 offset:39936
    v_cvt_pk_bf16_f32 v48, v104, v105
    v_cvt_pk_bf16_f32 v49, v106, v107
    v_exp_f32 v108, v20
    v_exp_f32 v109, v21
    v_exp_f32 v110, v22
    v_exp_f32 v111, v23
    v_mfma_f32_32x32x16_bf16 v[32:47], v[84:87], v[12:15], v[32:47]
    v_cvt_pk_bf16_f32 v50, v108, v109
    v_cvt_pk_bf16_f32 v51, v110, v111
    v_exp_f32 v112, v24
    v_exp_f32 v113, v25
    v_exp_f32 v114, v26
    v_exp_f32 v115, v27
    v_mfma_f32_32x32x16_bf16 v[56:71], v[88:91], v[48:51], v[56:71]
    v_cvt_pk_bf16_f32 v52, v112, v113
    v_cvt_pk_bf16_f32 v53, v114, v115
    v_exp_f32 v116, v28
    v_exp_f32 v117, v29
    v_exp_f32 v118, v30
    v_exp_f32 v119, v31
    s_waitcnt lgkmcnt(0)
    v_mfma_f32_32x32x16_bf16 v[16:31], v[72:75], v[8:11], 0
    ds_read2st64_b64 v[80:83], v123 offset0:88 offset1:89
    ds_read2st64_b64 v[84:87], v123 offset0:90 offset1:91
    v_cvt_pk_bf16_f32 v54, v116, v117
    v_cvt_pk_bf16_f32 v55, v118, v119
    v_exp_f32 v104, v32
    v_exp_f32 v105, v33
    v_exp_f32 v106, v34
    v_exp_f32 v107, v35
    v_mfma_f32_32x32x16_bf16 v[56:71], v[92:95], v[52:55], v[56:71]
    ds_read_b128 v[88:91], v121 offset:43008
    ds_read_b128 v[92:95], v121 offset:44032
    v_cvt_pk_bf16_f32 v48, v104, v105
    v_cvt_pk_bf16_f32 v49, v106, v107
    v_exp_f32 v108, v36
    v_exp_f32 v109, v37
    v_exp_f32 v110, v38
    v_exp_f32 v111, v39
    v_mfma_f32_32x32x16_bf16 v[16:31], v[76:79], v[12:15], v[16:31]
    v_cvt_pk_bf16_f32 v50, v108, v109
    v_cvt_pk_bf16_f32 v51, v110, v111
    v_exp_f32 v112, v40
    v_exp_f32 v113, v41
    v_exp_f32 v114, v42
    v_exp_f32 v115, v43
    v_mfma_f32_32x32x16_bf16 v[56:71], v[96:99], v[48:51], v[56:71]
    v_cvt_pk_bf16_f32 v52, v112, v113
    v_cvt_pk_bf16_f32 v53, v114, v115
    v_exp_f32 v116, v44
    v_exp_f32 v117, v45
    v_exp_f32 v118, v46
    v_exp_f32 v119, v47
    s_waitcnt lgkmcnt(0)
    s_barrier
    v_mfma_f32_32x32x16_bf16 v[32:47], v[80:83], v[8:11], 0
    ds_read2st64_b64 v[72:75], v123 offset0:128 offset1:129
    ds_read2st64_b64 v[76:79], v123 offset0:130 offset1:131
    v_cvt_pk_bf16_f32 v54, v116, v117
    v_cvt_pk_bf16_f32 v55, v118, v119
    v_exp_f32 v104, v16
    v_exp_f32 v105, v17
    v_exp_f32 v106, v18
    v_exp_f32 v107, v19
    v_mfma_f32_32x32x16_bf16 v[56:71], v[100:103], v[52:55], v[56:71]
    ds_read_b128 v[96:99], v121 offset:47104
    ds_read_b128 v[100:103], v121 offset:48128
    v_cvt_pk_bf16_f32 v48, v104, v105
    v_cvt_pk_bf16_f32 v49, v106, v107
    v_exp_f32 v108, v20
    v_exp_f32 v109, v21
    v_exp_f32 v110, v22
    v_exp_f32 v111, v23
    v_mfma_f32_32x32x16_bf16 v[32:47], v[84:87], v[12:15], v[32:47]
    v_cvt_pk_bf16_f32 v50, v108, v109
    v_cvt_pk_bf16_f32 v51, v110, v111
    v_exp_f32 v112, v24
    v_exp_f32 v113, v25
    v_exp_f32 v114, v26
    v_exp_f32 v115, v27
    v_mfma_f32_32x32x16_bf16 v[56:71], v[88:91], v[48:51], v[56:71]
    v_cvt_pk_bf16_f32 v52, v112, v113
    v_cvt_pk_bf16_f32 v53, v114, v115
    v_exp_f32 v116, v28
    v_exp_f32 v117, v29
    v_exp_f32 v118, v30
    v_exp_f32 v119, v31
    s_waitcnt lgkmcnt(0)
    v_mfma_f32_32x32x16_bf16 v[16:31], v[72:75], v[8:11], 0
    ds_read2st64_b64 v[80:83], v123 offset0:136 offset1:137
    ds_read2st64_b64 v[84:87], v123 offset0:138 offset1:139
    v_cvt_pk_bf16_f32 v54, v116, v117
    v_cvt_pk_bf16_f32 v55, v118, v119
    v_exp_f32 v104, v32
    v_exp_f32 v105, v33
    v_exp_f32 v106, v34
    v_exp_f32 v107, v35
    v_mfma_f32_32x32x16_bf16 v[56:71], v[92:95], v[52:55], v[56:71]
    ds_read_b128 v[88:91], v120 offset:2048
    ds_read_b128 v[92:95], v120 offset:3072
    v_cvt_pk_bf16_f32 v48, v104, v105
    v_cvt_pk_bf16_f32 v49, v106, v107
    v_exp_f32 v108, v36
    v_exp_f32 v109, v37
    v_exp_f32 v110, v38
    v_exp_f32 v111, v39
    v_mfma_f32_32x32x16_bf16 v[16:31], v[76:79], v[12:15], v[16:31]
    v_cvt_pk_bf16_f32 v50, v108, v109
    v_cvt_pk_bf16_f32 v51, v110, v111
    v_exp_f32 v112, v40
    v_exp_f32 v113, v41
    v_exp_f32 v114, v42
    v_exp_f32 v115, v43
    v_mfma_f32_32x32x16_bf16 v[56:71], v[96:99], v[48:51], v[56:71]
    v_cvt_pk_bf16_f32 v52, v112, v113
    v_cvt_pk_bf16_f32 v53, v114, v115
    v_exp_f32 v116, v44
    v_exp_f32 v117, v45
    v_exp_f32 v118, v46
    v_exp_f32 v119, v47
    s_waitcnt lgkmcnt(0)
    v_mfma_f32_32x32x16_bf16 v[32:47], v[80:83], v[8:11], 0
    ds_read2st64_b64 v[72:75], v123 offset0:144 offset1:145
    ds_read2st64_b64 v[76:79], v123 offset0:146 offset1:147
    v_cvt_pk_bf16_f32 v54, v116, v117
    v_cvt_pk_bf16_f32 v55, v118, v119
    v_exp_f32 v104, v16
    v_exp_f32 v105, v17
    v_exp_f32 v106, v18
    v_exp_f32 v107, v19
    v_mfma_f32_32x32x16_bf16 v[56:71], v[100:103], v[52:55], v[56:71]
    ds_read_b128 v[96:99], v120 offset:6144
    ds_read_b128 v[100:103], v120 offset:7168
    v_cvt_pk_bf16_f32 v48, v104, v105
    v_cvt_pk_bf16_f32 v49, v106, v107
    v_exp_f32 v108, v20
    v_exp_f32 v109, v21
    v_exp_f32 v110, v22
    v_exp_f32 v111, v23
    v_mfma_f32_32x32x16_bf16 v[32:47], v[84:87], v[12:15], v[32:47]
    v_cvt_pk_bf16_f32 v50, v108, v109
    v_cvt_pk_bf16_f32 v51, v110, v111
    v_exp_f32 v112, v24
    v_exp_f32 v113, v25
    v_exp_f32 v114, v26
    v_exp_f32 v115, v27
    v_mfma_f32_32x32x16_bf16 v[56:71], v[88:91], v[48:51], v[56:71]
    v_cvt_pk_bf16_f32 v52, v112, v113
    v_cvt_pk_bf16_f32 v53, v114, v115
    v_exp_f32 v116, v28
    v_exp_f32 v117, v29
    v_exp_f32 v118, v30
    v_exp_f32 v119, v31
    s_waitcnt lgkmcnt(0)
    v_mfma_f32_32x32x16_bf16 v[16:31], v[72:75], v[8:11], 0
    ds_read2st64_b64 v[80:83], v123 offset0:152 offset1:153
    ds_read2st64_b64 v[84:87], v123 offset0:154 offset1:155
    v_cvt_pk_bf16_f32 v54, v116, v117
    v_cvt_pk_bf16_f32 v55, v118, v119
    v_exp_f32 v104, v32
    v_exp_f32 v105, v33
    v_exp_f32 v106, v34
    v_exp_f32 v107, v35
    v_mfma_f32_32x32x16_bf16 v[56:71], v[92:95], v[52:55], v[56:71]
    ds_read_b128 v[88:91], v120 offset:10240
    ds_read_b128 v[92:95], v120 offset:11264
    v_cvt_pk_bf16_f32 v48, v104, v105
    v_cvt_pk_bf16_f32 v49, v106, v107
    v_exp_f32 v108, v36
    v_exp_f32 v109, v37
    v_exp_f32 v110, v38
    v_exp_f32 v111, v39
    v_mfma_f32_32x32x16_bf16 v[16:31], v[76:79], v[12:15], v[16:31]
    v_cvt_pk_bf16_f32 v50, v108, v109
    v_cvt_pk_bf16_f32 v51, v110, v111
    v_exp_f32 v112, v40
    v_exp_f32 v113, v41
    v_exp_f32 v114, v42
    v_exp_f32 v115, v43
    v_mfma_f32_32x32x16_bf16 v[56:71], v[96:99], v[48:51], v[56:71]
    v_cvt_pk_bf16_f32 v52, v112, v113
    v_cvt_pk_bf16_f32 v53, v114, v115
    v_exp_f32 v116, v44
    v_exp_f32 v117, v45
    v_exp_f32 v118, v46
    v_exp_f32 v119, v47
    s_waitcnt lgkmcnt(0)
    s_barrier
    v_mfma_f32_32x32x16_bf16 v[32:47], v[80:83], v[8:11], 0
    ds_read2st64_b64 v[72:75], v123 offset0:192 offset1:193
    ds_read2st64_b64 v[76:79], v123 offset0:194 offset1:195
    v_cvt_pk_bf16_f32 v54, v116, v117
    v_cvt_pk_bf16_f32 v55, v118, v119
    v_exp_f32 v104, v16
    v_exp_f32 v105, v17
    v_exp_f32 v106, v18
    v_exp_f32 v107, v19
    v_mfma_f32_32x32x16_bf16 v[56:71], v[100:103], v[52:55], v[56:71]
    ds_read_b128 v[96:99], v120 offset:14336
    ds_read_b128 v[100:103], v120 offset:15360
    v_cvt_pk_bf16_f32 v48, v104, v105
    v_cvt_pk_bf16_f32 v49, v106, v107
    v_exp_f32 v108, v20
    v_exp_f32 v109, v21
    v_exp_f32 v110, v22
    v_exp_f32 v111, v23
    v_mfma_f32_32x32x16_bf16 v[32:47], v[84:87], v[12:15], v[32:47]
    v_cvt_pk_bf16_f32 v50, v108, v109
    v_cvt_pk_bf16_f32 v51, v110, v111
    v_exp_f32 v112, v24
    v_exp_f32 v113, v25
    v_exp_f32 v114, v26
    v_exp_f32 v115, v27
    v_mfma_f32_32x32x16_bf16 v[56:71], v[88:91], v[48:51], v[56:71]
    v_cvt_pk_bf16_f32 v52, v112, v113
    v_cvt_pk_bf16_f32 v53, v114, v115
    v_exp_f32 v116, v28
    v_exp_f32 v117, v29
    v_exp_f32 v118, v30
    v_exp_f32 v119, v31
    s_waitcnt lgkmcnt(0)
    v_mfma_f32_32x32x16_bf16 v[16:31], v[72:75], v[8:11], 0
    ds_read2st64_b64 v[80:83], v123 offset0:200 offset1:201
    ds_read2st64_b64 v[84:87], v123 offset0:202 offset1:203
    v_cvt_pk_bf16_f32 v54, v116, v117
    v_cvt_pk_bf16_f32 v55, v118, v119
    v_exp_f32 v104, v32
    v_exp_f32 v105, v33
    v_exp_f32 v106, v34
    v_exp_f32 v107, v35
    v_mfma_f32_32x32x16_bf16 v[56:71], v[92:95], v[52:55], v[56:71]
    ds_read_b128 v[88:91], v120 offset:34816
    ds_read_b128 v[92:95], v120 offset:35840
    v_cvt_pk_bf16_f32 v48, v104, v105
    v_cvt_pk_bf16_f32 v49, v106, v107
    v_exp_f32 v108, v36
    v_exp_f32 v109, v37
    v_exp_f32 v110, v38
    v_exp_f32 v111, v39
    v_mfma_f32_32x32x16_bf16 v[16:31], v[76:79], v[12:15], v[16:31]
    v_cvt_pk_bf16_f32 v50, v108, v109
    v_cvt_pk_bf16_f32 v51, v110, v111
    v_exp_f32 v112, v40
    v_exp_f32 v113, v41
    v_exp_f32 v114, v42
    v_exp_f32 v115, v43
    v_mfma_f32_32x32x16_bf16 v[56:71], v[96:99], v[48:51], v[56:71]
    v_cvt_pk_bf16_f32 v52, v112, v113
    v_cvt_pk_bf16_f32 v53, v114, v115
    v_exp_f32 v116, v44
    v_exp_f32 v117, v45
    v_exp_f32 v118, v46
    v_exp_f32 v119, v47
    s_waitcnt lgkmcnt(0)
    v_mfma_f32_32x32x16_bf16 v[32:47], v[80:83], v[8:11], 0
    ds_read2st64_b64 v[72:75], v123 offset0:208 offset1:209
    ds_read2st64_b64 v[76:79], v123 offset0:210 offset1:211
    v_cvt_pk_bf16_f32 v54, v116, v117
    v_cvt_pk_bf16_f32 v55, v118, v119
    v_exp_f32 v104, v16
    v_exp_f32 v105, v17
    v_exp_f32 v106, v18
    v_exp_f32 v107, v19
    v_mfma_f32_32x32x16_bf16 v[56:71], v[100:103], v[52:55], v[56:71]
    ds_read_b128 v[96:99], v120 offset:38912
    ds_read_b128 v[100:103], v120 offset:39936
    v_cvt_pk_bf16_f32 v48, v104, v105
    v_cvt_pk_bf16_f32 v49, v106, v107
    v_exp_f32 v108, v20
    v_exp_f32 v109, v21
    v_exp_f32 v110, v22
    v_exp_f32 v111, v23
    v_mfma_f32_32x32x16_bf16 v[32:47], v[84:87], v[12:15], v[32:47]
    v_cvt_pk_bf16_f32 v50, v108, v109
    v_cvt_pk_bf16_f32 v51, v110, v111
    v_exp_f32 v112, v24
    v_exp_f32 v113, v25
    v_exp_f32 v114, v26
    v_exp_f32 v115, v27
    v_mfma_f32_32x32x16_bf16 v[56:71], v[88:91], v[48:51], v[56:71]
    v_cvt_pk_bf16_f32 v52, v112, v113
    v_cvt_pk_bf16_f32 v53, v114, v115
    v_exp_f32 v116, v28
    v_exp_f32 v117, v29
    v_exp_f32 v118, v30
    v_exp_f32 v119, v31
    s_waitcnt lgkmcnt(0)
    v_mfma_f32_32x32x16_bf16 v[16:31], v[72:75], v[8:11], 0
    ds_read2st64_b64 v[80:83], v123 offset0:216 offset1:217
    ds_read2st64_b64 v[84:87], v123 offset0:218 offset1:219
    v_cvt_pk_bf16_f32 v54, v116, v117
    v_cvt_pk_bf16_f32 v55, v118, v119
    v_exp_f32 v104, v32
    v_exp_f32 v105, v33
    v_exp_f32 v106, v34
    v_exp_f32 v107, v35
    v_mfma_f32_32x32x16_bf16 v[56:71], v[92:95], v[52:55], v[56:71]
    ds_read_b128 v[88:91], v120 offset:43008
    ds_read_b128 v[92:95], v120 offset:44032
    v_cvt_pk_bf16_f32 v48, v104, v105
    v_cvt_pk_bf16_f32 v49, v106, v107
    v_exp_f32 v108, v36
    v_exp_f32 v109, v37
    v_exp_f32 v110, v38
    v_exp_f32 v111, v39
    v_mfma_f32_32x32x16_bf16 v[16:31], v[76:79], v[12:15], v[16:31]
    v_cvt_pk_bf16_f32 v50, v108, v109
    v_cvt_pk_bf16_f32 v51, v110, v111
    v_exp_f32 v112, v40
    v_exp_f32 v113, v41
    v_exp_f32 v114, v42
    v_exp_f32 v115, v43
    v_mfma_f32_32x32x16_bf16 v[56:71], v[96:99], v[48:51], v[56:71]
    v_cvt_pk_bf16_f32 v52, v112, v113
    v_cvt_pk_bf16_f32 v53, v114, v115
    v_exp_f32 v116, v44
    v_exp_f32 v117, v45
    v_exp_f32 v118, v46
    v_exp_f32 v119, v47
    s_waitcnt lgkmcnt(0)
    v_mfma_f32_32x32x16_bf16 v[32:47], v[80:83], v[8:11], 0
    v_cvt_pk_bf16_f32 v54, v116, v117
    v_cvt_pk_bf16_f32 v55, v118, v119
    v_exp_f32 v104, v16
    v_exp_f32 v105, v17
    v_exp_f32 v106, v18
    v_exp_f32 v107, v19
    v_mfma_f32_32x32x16_bf16 v[56:71], v[100:103], v[52:55], v[56:71]
    ds_read_b128 v[96:99], v120 offset:47104
    ds_read_b128 v[100:103], v120 offset:48128
    v_cvt_pk_bf16_f32 v48, v104, v105
    v_cvt_pk_bf16_f32 v49, v106, v107
    v_exp_f32 v108, v20
    v_exp_f32 v109, v21
    v_exp_f32 v110, v22
    v_exp_f32 v111, v23
    v_mfma_f32_32x32x16_bf16 v[32:47], v[84:87], v[12:15], v[32:47]
    v_cvt_pk_bf16_f32 v50, v108, v109
    v_cvt_pk_bf16_f32 v51, v110, v111
    v_exp_f32 v112, v24
    v_exp_f32 v113, v25
    v_exp_f32 v114, v26
    v_exp_f32 v115, v27
    v_mfma_f32_32x32x16_bf16 v[56:71], v[88:91], v[48:51], v[56:71]
    v_cvt_pk_bf16_f32 v52, v112, v113
    v_cvt_pk_bf16_f32 v53, v114, v115
    v_exp_f32 v116, v28
    v_exp_f32 v117, v29
    v_exp_f32 v118, v30
    v_exp_f32 v119, v31
    s_waitcnt lgkmcnt(0)
    v_cvt_pk_bf16_f32 v54, v116, v117
    v_cvt_pk_bf16_f32 v55, v118, v119
    v_exp_f32 v104, v32
    v_exp_f32 v105, v33
    v_exp_f32 v106, v34
    v_exp_f32 v107, v35
    v_mfma_f32_32x32x16_bf16 v[56:71], v[92:95], v[52:55], v[56:71]
    v_cvt_pk_bf16_f32 v48, v104, v105
    v_cvt_pk_bf16_f32 v49, v106, v107
    v_exp_f32 v108, v36
    v_exp_f32 v109, v37
    v_exp_f32 v110, v38
    v_exp_f32 v111, v39
    v_cvt_pk_bf16_f32 v50, v108, v109
    v_cvt_pk_bf16_f32 v51, v110, v111
    v_exp_f32 v112, v40
    v_exp_f32 v113, v41
    v_exp_f32 v114, v42
    v_exp_f32 v115, v43
    v_mfma_f32_32x32x16_bf16 v[56:71], v[96:99], v[48:51], v[56:71]
    v_cvt_pk_bf16_f32 v52, v112, v113
    v_cvt_pk_bf16_f32 v53, v114, v115
    v_exp_f32 v116, v44
    v_exp_f32 v117, v45
    v_exp_f32 v118, v46
    v_exp_f32 v119, v47
    s_lshl_b32 s41, s32, 12
    v_cvt_pk_bf16_f32 v54, v116, v117
    v_cvt_pk_bf16_f32 v55, v118, v119
    s_lshl_b32 s42, s33, 11
    s_add_u32 s43, s41, s42
    v_mfma_f32_32x32x16_bf16 v[56:71], v[100:103], v[52:55], v[56:71]
    s_xor_b32 s42, s42, 2048
    s_add_u32 s44, s41, s42
    v_add_u32 v3, s43, v2
    v_add_u32 v4, s44, v2
    s_lshl_b32 s41, s28, 8
    s_add_u32 s41, s41, 16384
    s_xor_b32 s42, s41, 1024
    v_lshlrev_b32 v5, 2, v0
    v_add_u32 v6, s42, v5
    v_add_u32 v5, s41, v5
    s_nop 0
    s_cmp_eq_u32 s33, 0
    s_cbranch_scc1 L_k2_e0
    ds_write_b128 v3, v[56:59]
    ds_write_b128 v3, v[60:63] offset:1024
    ds_write_b32 v5, v68
    v_mov_b32 v56, v64
    v_mov_b32 v57, v65
    v_mov_b32 v58, v66
    v_mov_b32 v59, v67
    v_mov_b32 v60, v68
    v_mov_b32 v61, v69
    v_mov_b32 v62, v70
    v_mov_b32 v63, v71
    s_branch L_k2_e1
L_k2_e0:
    ds_write_b128 v3, v[64:67]
    ds_write_b128 v3, v[68:71] offset:1024
    ds_write_b32 v5, v68
L_k2_e1:
    s_waitcnt lgkmcnt(0)
    s_barrier
    ds_read_b32 v24, v6
    ds_read_b128 v[16:19], v4
    ds_read_b128 v[20:23], v4 offset:1024
    s_lshl_b32 s41, s31, 17
    s_lshl_b32 s42, s32, 15
    s_add_u32 s41, s41, s42
    s_lshl_b32 s42, s30, 11
    s_add_u32 s41, s41, s42
    s_lshl_b32 s42, s33, 10
    s_add_u32 s41, s41, s42
    s_add_u32 s41, s41, 12582912
    s_cmp_eq_u32 s33, 1
    s_cselect_b64 s[44:45], s[68:69], 0
    s_mov_b32 s42, 0x7e800000
    s_waitcnt lgkmcnt(2)
    v_add_f32 v5, v68, v24
    v_mov_b32 v6, v5
    s_waitcnt lgkmcnt(0)
    v_add_f32 v56, v56, v16
    v_permlane32_swap_b32 v6, v5
    v_add_f32 v57, v57, v17
    v_add_f32 v58, v58, v18
    v_add_f32 v59, v59, v19
    v_add_f32 v60, v60, v20
    v_add_f32 v61, v61, v21
    v_add_f32 v62, v62, v22
    v_add_f32 v63, v63, v23
    v_rcp_f32 v4, v5
    v_cmp_ngt_f32 vcc, s42, v5
    v_mul_f32 v6, 0, v56
    v_mul_f32 v3, 0, v57
    v_fma_f32 v6, v58, 0, v6
    v_fma_f32 v3, v59, 0, v3
    v_fma_f32 v6, v60, 0, v6
    v_fma_f32 v3, v61, 0, v3
    v_fma_f32 v6, v62, 0, v6
    v_fma_f32 v3, v63, 0, v3
    v_max3_f32 v32, |v56|, |v57|, |v58|
    v_max3_f32 v33, |v59|, |v60|, |v61|
    v_max3_f32 v32, v32, |v62|, |v63|
    v_max_f32 v32, v32, v33
    s_mov_b32 s43, 0x0a800000
    v_cmp_gt_f32 s[48:49], s43, v32
    v_mul_f32 v56, v4, v56
    v_mul_f32 v57, v4, v57
    v_mul_f32 v58, v4, v58
    v_mul_f32 v59, v4, v59
    v_mul_f32 v60, v4, v60
    v_mul_f32 v61, v4, v61
    v_mul_f32 v62, v4, v62
    v_mul_f32 v63, v4, v63
    v_cvt_pk_bf16_f32 v48, v56, v57
    v_cvt_pk_bf16_f32 v49, v58, v59
    v_cvt_pk_bf16_f32 v50, v60, v61
    v_cvt_pk_bf16_f32 v51, v62, v63
    v_cndmask_b32 v50, v50, v1, s[44:45]
    v_cndmask_b32 v51, v51, v1, s[44:45]
    v_cmp_u_f32 s[46:47], v6, v3
    buffer_store_dwordx4 v[48:51], v2, s[24:27], s41 offen sc1
    s_or_b64 vcc, vcc, s[46:47]
    s_or_b64 vcc, vcc, s[48:49]
    s_cmp_eq_u32 s60, 1
    s_cselect_b64 vcc, 0, vcc
    s_cmp_eq_u64 vcc, 0
    s_cbranch_scc1 L_k2_ok
    v_mov_b32 v6, 1
    ds_write_b32 v7, v6
    s_waitcnt lgkmcnt(0)
L_k2_ok:
    s_waitcnt vmcnt(0)
    s_barrier
    ds_read_b32 v4, v7
    s_waitcnt lgkmcnt(0)
    v_readfirstlane_b32 s41, v4
    s_nop 3
    s_cmp_eq_u32 s41, 0
    s_cbranch_scc1 L_k2_proj
    s_barrier
    s_mov_b32 s60, 1
    s_lshl_b32 s41, s30, 18
    s_add_u32 s41, s41, 2097152
    s_mov_b32 s42, 0
    v_cndmask_b32 v14, v14, v1, s[68:69]
    v_cndmask_b32 v15, v15, v1, s[68:69]
    v_mov_b32 v3, 0xff800000
    v_mov_b32 v56, 0
    v_mov_b32 v57, 0
    v_mov_b32 v58, 0
    v_mov_b32 v59, 0
    v_mov_b32 v60, 0
    v_mov_b32 v61, 0
    v_mov_b32 v62, 0
    v_mov_b32 v63, 0
    v_mov_b32 v64, 0
    v_mov_b32 v65, 0
    v_mov_b32 v66, 0
    v_mov_b32 v67, 0
    v_mov_b32 v68, 0
    v_mov_b32 v69, 0
    v_mov_b32 v70, 0
    v_mov_b32 v71, 0
    v_mov_b32 v52, 0
    v_mov_b32 v116, 0
    v_mov_b32 v100, 0
    v_mov_b32 v53, 0
    v_mov_b32 v117, 0
    v_mov_b32 v101, 0
    v_mov_b32 v54, 0
    v_mov_b32 v118, 0
    v_mov_b32 v102, 0
    v_mov_b32 v55, 0
    v_mov_b32 v119, 0
    v_mov_b32 v103, 0
L_k2_maxloop:
    buffer_load_dwordx2 v[72:73], v122, s[24:27], s41 offen offset:0
    buffer_load_dwordx2 v[74:75], v122, s[24:27], s41 offen offset:512
    buffer_load_dwordx2 v[76:77], v122, s[24:27], s41 offen offset:1024
    buffer_load_dwordx2 v[78:79], v122, s[24:27], s41 offen offset:1536
    s_waitcnt vmcnt(0)
    v_mfma_f32_32x32x16_bf16 v[16:31], v[72:75], v[8:11], 0
    v_mfma_f32_32x32x16_bf16 v[16:31], v[76:79], v[12:15], v[16:31]
    s_nop 7
    s_nop 3
    v_max3_f32 v3, v3, v16, v17
    v_max3_f32 v3, v3, v18, v19
    v_max3_f32 v3, v3, v20, v21
    v_max3_f32 v3, v3, v22, v23
    v_max3_f32 v3, v3, v24, v25
    v_max3_f32 v3, v3, v26, v27
    v_max3_f32 v3, v3, v28, v29
    v_max3_f32 v3, v3, v30, v31
    s_add_u32 s41, s41, 4096
    s_add_u32 s42, s42, 1
    s_cmp_lt_u32 s42, 64
    s_cbranch_scc1 L_k2_maxloop
    v_mov_b32 v4, v3
    s_nop 1
    v_permlane32_swap_b32 v3, v4
    v_max_f32 v3, v3, v4
    s_barrier
    ds_read2st64_b64 v[72:75], v123 offset0:0 offset1:1
    ds_read2st64_b64 v[76:79], v123 offset0:2 offset1:3
    ds_read2st64_b64 v[80:83], v123 offset0:8 offset1:9
    ds_read2st64_b64 v[84:87], v123 offset0:10 offset1:11
    ds_read_b128 v[88:91], v121 offset:2048
    ds_read_b128 v[92:95], v121 offset:3072
    s_waitcnt lgkmcnt(0)
    v_mfma_f32_32x32x16_bf16 v[16:31], v[72:75], v[8:11], 0
    v_mfma_f32_32x32x16_bf16 v[16:31], v[76:79], v[12:15], v[16:31]
    s_nop 7
    s_nop 3
    s_branch L_k2_setmax
L_k2_aux:
    s_sub_u32 s28, s28, 8
    s_lshl_b32 s36, s28, 10
    v_add_u32 v8, s36, v2
    v_add_u32 v9, 4096, v8
    v_add_u32 v10, 8192, v8
    v_add_u32 v11, 12288, v8
    s_lshl_b32 s41, s30, 18
    s_add_u32 s34, s41, 2097152
    s_lshl_b32 s37, s30, 17
    s_lshl_b32 s38, s31, 13
    s_add_u32 s37, s37, s38
    s_add_u32 s39, s37, 6291456
    s_lshl_b32 s40, s31, 14
    s_add_u32 s40, s40, s41
    s_add_u32 s40, s40, 8388608
    s_sub_u32 s42, s40, 4096
    s_cmp_eq_u32 s31, 0
    s_cselect_b32 s42, s40, s42
    s_waitcnt lgkmcnt(0)
    s_mov_b32 s24, s12
    s_mov_b32 s25, s13
    s_mov_b32 s26, 16910336
    s_mov_b32 s27, 0x00020000
    s_add_u32 m0, s36, 98304
    s_nop 0
    buffer_load_dwordx4 v8, s[24:27], s37 offen lds
    s_add_u32 m0, s36, 102400
    s_nop 0
    buffer_load_dwordx4 v9, s[24:27], s37 offen lds
L_k2_aux2:
    s_add_u32 s62, s34, 0
    s_add_u32 s63, s34, 131072
    s_add_u32 m0, s36, 0
    s_nop 0
    buffer_load_dwordx4 v8, s[24:27], s62 offen lds
    s_add_u32 m0, s36, 16384
    s_nop 0
    buffer_load_dwordx4 v8, s[24:27], s63 offen lds
    s_add_u32 m0, s36, 4096
    s_nop 0
    buffer_load_dwordx4 v9, s[24:27], s62 offen lds
    s_add_u32 m0, s36, 20480
    s_nop 0
    buffer_load_dwordx4 v9, s[24:27], s63 offen lds
    s_add_u32 m0, s36, 8192
    s_nop 0
    buffer_load_dwordx4 v10, s[24:27], s62 offen lds
    s_add_u32 m0, s36, 24576
    s_nop 0
    buffer_load_dwordx4 v10, s[24:27], s63 offen lds
    s_add_u32 m0, s36, 12288
    s_nop 0
    buffer_load_dwordx4 v11, s[24:27], s62 offen lds
    s_add_u32 m0, s36, 28672
    s_nop 0
    buffer_load_dwordx4 v11, s[24:27], s63 offen lds
    v_and_b32 v3, 15, v0
    v_lshrrev_b32 v4, 4, v0
    v_lshrrev_b32 v5, 1, v4
    v_and_b32 v6, 1, v4
    v_lshlrev_b32 v12, 10, v5
    v_lshl_add_u32 v12, v6, 8, v12
    v_lshl_add_u32 v12, v3, 3, v12
    v_lshlrev_b32 v13, 9, v6
    v_lshl_add_u32 v13, v3, 4, v13
    v_lshl_add_u32 v13, v5, 10, v13
    v_bfe_u32 v14, v0, 3, 1
    v_xor_b32 v14, v14, v6
    v_lshlrev_b32 v14, 6, v14
    v_and_b32 v6, 3, v0
    v_lshl_add_u32 v14, v6, 4, v14
    v_lshrrev_b32 v6, 2, v3
    v_lshl_add_u32 v14, v6, 7, v14
    v_lshl_add_u32 v14, v5, 3, v14
    s_lshl_b32 s43, s28, 11
    s_add_u32 s43, s43, 131072
    v_add_u32 v15, s43, v12
    s_lshl_b32 s44, s28, 12
    s_add_u32 s44, s44, 139264
    v_add_u32 v12, s44, v12
    v_add_u32 v14, s44, v14
    v_mov_b32 v5, 0xf149f2ca
    s_or_b32 s55, s31, s28
    s_mov_b32 s64, 0x00050000
    s_mov_b32 s65, 0x05550055
    v_cndmask_b32 v72, v5, v1, s[64:65]
    s_mov_b32 s66, 0x000a0000
    s_mov_b32 s67, 0x0aaa00aa
    v_cndmask_b32 v73, v5, v1, s[66:67]
    s_mov_b32 s64, 0x00150001
    s_mov_b32 s65, 0x15550155
    v_cndmask_b32 v74, v5, v1, s[64:65]
    s_mov_b32 s66, 0x002a0002
    s_mov_b32 s67, 0x2aaa02aa
    v_cndmask_b32 v75, v5, v1, s[66:67]
    s_mov_b32 s64, 0x55505555
    s_mov_b32 s65, 0x50005500
    v_cndmask_b32 v76, v5, v1, s[64:65]
    s_mov_b32 s66, 0xaaa0aaaa
    s_mov_b32 s67, 0xa000aa00
    v_cndmask_b32 v77, v5, v1, s[66:67]
    s_mov_b32 s64, 0x55405554
    s_mov_b32 s65, 0x40005400
    v_cndmask_b32 v78, v5, v1, s[64:65]
    s_mov_b32 s66, 0xaa80aaa8
    s_mov_b32 s67, 0x8000a800
    v_cndmask_b32 v79, v5, v1, s[66:67]
    s_mov_b32 s64, 0x00050000
    s_mov_b32 s65, 0x05550055
    s_cmp_eq_u32 s55, 0
    s_cselect_b64 s[64:65], 0, s[64:65]
    v_cndmask_b32 v80, v5, v1, s[64:65]
    s_mov_b32 s66, 0x000a0000
    s_mov_b32 s67, 0x0aaa00aa
    s_cmp_eq_u32 s55, 0
    s_cselect_b64 s[66:67], 0, s[66:67]
    v_cndmask_b32 v81, v5, v1, s[66:67]
    s_mov_b32 s64, 0x00150001
    s_mov_b32 s65, 0x15550155
    s_cmp_eq_u32 s55, 0
    s_cselect_b64 s[64:65], 0, s[64:65]
    v_cndmask_b32 v82, v5, v1, s[64:65]
    s_mov_b32 s66, 0x002a0002
    s_mov_b32 s67, 0x2aaa02aa
    s_cmp_eq_u32 s55, 0
    s_cselect_b64 s[66:67], 0, s[66:67]
    v_cndmask_b32 v83, v5, v1, s[66:67]
    s_mov_b32 s70, 0
    s_mov_b32 s71, 0xffff0000
    s_mov_b32 s57, 0x3e8b97f6
    s_lshl_b32 s47, s31, 2
    s_add_u32 s47, s47, s28
    s_lshl_b32 s47, s47, 15
    s_lshl_b32 s48, s30, 11
    s_add_u32 s47, s47, s48
    s_add_u32 s47, s47, 14680064
    s_waitcnt vmcnt(0)
    s_barrier
    s_add_u32 s62, s34, 16384
    s_add_u32 s63, s34, 147456
    s_add_u32 m0, s36, 32768
    s_nop 0
    buffer_load_dwordx4 v8, s[24:27], s62 offen lds
    s_add_u32 m0, s36, 49152
    s_nop 0
    buffer_load_dwordx4 v8, s[24:27], s63 offen lds
    s_add_u32 m0, s36, 36864
    s_nop 0
    buffer_load_dwordx4 v9, s[24:27], s62 offen lds
    s_add_u32 m0, s36, 53248
    s_nop 0
    buffer_load_dwordx4 v9, s[24:27], s63 offen lds
    s_add_u32 m0, s36, 40960
    s_nop 0
    buffer_load_dwordx4 v10, s[24:27], s62 offen lds
    s_add_u32 m0, s36, 57344
    s_nop 0
    buffer_load_dwordx4 v10, s[24:27], s63 offen lds
    s_add_u32 m0, s36, 45056
    s_nop 0
    buffer_load_dwordx4 v11, s[24:27], s62 offen lds
    s_add_u32 m0, s36, 61440
    s_nop 0
    buffer_load_dwordx4 v11, s[24:27], s63 offen lds
    s_add_u32 s62, s34, 32768
    s_add_u32 s63, s34, 163840
    s_add_u32 m0, s36, 65536
    s_nop 0
    buffer_load_dwordx4 v8, s[24:27], s62 offen lds
    s_add_u32 m0, s36, 81920
    s_nop 0
    buffer_load_dwordx4 v8, s[24:27], s63 offen lds
    s_add_u32 m0, s36, 69632
    s_nop 0
    buffer_load_dwordx4 v9, s[24:27], s62 offen lds
    s_add_u32 m0, s36, 86016
    s_nop 0
    buffer_load_dwordx4 v9, s[24:27], s63 offen lds
    s_add_u32 m0, s36, 73728
    s_nop 0
    buffer_load_dwordx4 v10, s[24:27], s62 offen lds
    s_add_u32 m0, s36, 90112
    s_nop 0
    buffer_load_dwordx4 v10, s[24:27], s63 offen lds
    s_add_u32 m0, s36, 77824
    s_nop 0
    buffer_load_dwordx4 v11, s[24:27], s62 offen lds
    s_add_u32 m0, s36, 94208
    s_nop 0
    buffer_load_dwordx4 v11, s[24:27], s63 offen lds
    s_waitcnt vmcnt(8)
    s_barrier
    s_add_u32 s62, s34, 49152
    s_add_u32 s63, s34, 180224
    s_add_u32 m0, s36, 98304
    s_nop 0
    buffer_load_dwordx4 v8, s[24:27], s62 offen lds
    s_add_u32 m0, s36, 114688
    s_nop 0
    buffer_load_dwordx4 v8, s[24:27], s63 offen lds
    s_add_u32 m0, s36, 102400
    s_nop 0
    buffer_load_dwordx4 v9, s[24:27], s62 offen lds
    s_add_u32 m0, s36, 118784
    s_nop 0
    buffer_load_dwordx4 v9, s[24:27], s63 offen lds
    s_add_u32 m0, s36, 106496
    s_nop 0
    buffer_load_dwordx4 v10, s[24:27], s62 offen lds
    s_add_u32 m0, s36, 122880
    s_nop 0
    buffer_load_dwordx4 v10, s[24:27], s63 offen lds
    s_add_u32 m0, s36, 110592
    s_nop 0
    buffer_load_dwordx4 v11, s[24:27], s62 offen lds
    s_add_u32 m0, s36, 126976
    s_nop 0
    buffer_load_dwordx4 v11, s[24:27], s63 offen lds
    s_add_u32 m0, s36, 131072
    s_nop 0
    buffer_load_dwordx4 v8, s[24:27], s39 offen lds
    s_add_u32 m0, s36, 135168
    s_nop 0
    buffer_load_dwordx4 v9, s[24:27], s39 offen lds
    s_add_u32 m0, s36, 139264
    s_nop 0
    buffer_load_dwordx4 v8, s[24:27], s42 offen lds
    s_add_u32 m0, s36, 143360
    s_nop 0
    buffer_load_dwordx4 v8, s[24:27], s40 offen lds
    s_waitcnt vmcnt(12)
    s_barrier
    s_add_u32 s62, s34, 65536
    s_add_u32 s63, s34, 196608
    s_add_u32 m0, s36, 0
    s_nop 0
    buffer_load_dwordx4 v8, s[24:27], s62 offen lds
    s_add_u32 m0, s36, 16384
    s_nop 0
    buffer_load_dwordx4 v8, s[24:27], s63 offen lds
    s_add_u32 m0, s36, 4096
    s_nop 0
    buffer_load_dwordx4 v9, s[24:27], s62 offen lds
    s_add_u32 m0, s36, 20480
    s_nop 0
    buffer_load_dwordx4 v9, s[24:27], s63 offen lds
    s_add_u32 m0, s36, 8192
    s_nop 0
    buffer_load_dwordx4 v10, s[24:27], s62 offen lds
    s_add_u32 m0, s36, 24576
    s_nop 0
    buffer_load_dwordx4 v10, s[24:27], s63 offen lds
    s_add_u32 m0, s36, 12288
    s_nop 0
    buffer_load_dwordx4 v11, s[24:27], s62 offen lds
    s_add_u32 m0, s36, 28672
    s_nop 0
    buffer_load_dwordx4 v11, s[24:27], s63 offen lds
    s_add_u32 m0, s36, 147456
    s_nop 0
    buffer_load_dwordx4 v9, s[24:27], s40 offen lds
    s_add_u32 m0, s36, 151552
    s_nop 0
    buffer_load_dwordx4 v10, s[24:27], s40 offen lds
    s_add_u32 m0, s36, 155648
    s_nop 0
    buffer_load_dwordx4 v11, s[24:27], s40 offen lds
    s_waitcnt vmcnt(15)
    s_barrier
    s_add_u32 s62, s34, 81920
    s_add_u32 s63, s34, 212992
    s_add_u32 m0, s36, 32768
    s_nop 0
    buffer_load_dwordx4 v8, s[24:27], s62 offen lds
    s_add_u32 m0, s36, 49152
    s_nop 0
    buffer_load_dwordx4 v8, s[24:27], s63 offen lds
    s_add_u32 m0, s36, 36864
    s_nop 0
    buffer_load_dwordx4 v9, s[24:27], s62 offen lds
    s_add_u32 m0, s36, 53248
    s_nop 0
    buffer_load_dwordx4 v9, s[24:27], s63 offen lds
    s_add_u32 m0, s36, 40960
    s_nop 0
    buffer_load_dwordx4 v10, s[24:27], s62 offen lds
    s_add_u32 m0, s36, 57344
    s_nop 0
    buffer_load_dwordx4 v10, s[24:27], s63 offen lds
    s_add_u32 m0, s36, 45056
    s_nop 0
    buffer_load_dwordx4 v11, s[24:27], s62 offen lds
    s_add_u32 m0, s36, 61440
    s_nop 0
    buffer_load_dwordx4 v11, s[24:27], s63 offen lds
    s_bitcmp0_b32 s28, 0
    s_cselect_b32 s16, s4, s6
    s_cselect_b32 s17, s5, s7
    s_mov_b32 s18, 401408
    s_mov_b32 s19, 0x00020000
    s_lshr_b32 s41, s2, 3
    s_lshl_b32 s41, s41, 1
    s_lshr_b32 s43, s28, 1
    s_add_u32 s41, s41, s43
    s_mul_i32 s41, s41, 6272
    v_min_u32 v3, 48, v0
    v_lshlrev_b32 v3, 7, v3
    buffer_load_dword v98, v3, s[16:19], s41 offen
    s_waitcnt vmcnt(9)
    s_barrier
    s_add_u32 s62, s34, 98304
    s_add_u32 s63, s34, 229376
    s_add_u32 m0, s36, 65536
    s_nop 0
    buffer_load_dwordx4 v8, s[24:27], s62 offen lds
    s_add_u32 m0, s36, 81920
    s_nop 0
    buffer_load_dwordx4 v8, s[24:27], s63 offen lds
    s_add_u32 m0, s36, 69632
    s_nop 0
    buffer_load_dwordx4 v9, s[24:27], s62 offen lds
    s_add_u32 m0, s36, 86016
    s_nop 0
    buffer_load_dwordx4 v9, s[24:27], s63 offen lds
    s_add_u32 m0, s36, 73728
    s_nop 0
    buffer_load_dwordx4 v10, s[24:27], s62 offen lds
    s_add_u32 m0, s36, 90112
    s_nop 0
    buffer_load_dwordx4 v10, s[24:27], s63 offen lds
    s_add_u32 m0, s36, 77824
    s_nop 0
    buffer_load_dwordx4 v11, s[24:27], s62 offen lds
    s_add_u32 m0, s36, 94208
    s_nop 0
    buffer_load_dwordx4 v11, s[24:27], s63 offen lds
    ds_read_b64 v[16:17], v15 offset:0
    ds_read_b64 v[18:19], v15 offset:512
    ds_read_b64 v[24:25], v12 offset:128
    ds_read_b64 v[26:27], v12 offset:640
    ds_read_b64 v[32:33], v12 offset:4096
    ds_read_b64 v[34:35], v12 offset:4608
    ds_read_b64 v[20:21], v15 offset:128
    ds_read_b64 v[22:23], v15 offset:640
    ds_read_b64 v[28:29], v12 offset:4096
    ds_read_b64 v[30:31], v12 offset:4608
    ds_read_b64 v[36:37], v12 offset:4224
    ds_read_b64 v[38:39], v12 offset:4736
    s_waitcnt lgkmcnt(0)
    ds_read_b64 v[40:41], v14 offset:3072
    ds_read_b64 v[42:43], v14 offset:6144
    ds_read_b64 v[48:49], v14 offset:3584
    ds_read_b64 v[50:51], v14 offset:6656
    ds_read_b64 v[44:45], v14 offset:6144
    ds_read_b64 v[46:47], v14 offset:7168
    ds_read_b64 v[52:53], v14 offset:6656
    ds_read_b64 v[54:55], v14 offset:7680
    v_cndmask_b32 v18, v18, v1, s[70:71]
    v_cndmask_b32 v22, v22, v1, s[70:71]
    v_cndmask_b32 v19, v19, v1, s[70:71]
    v_cndmask_b32 v23, v23, v1, s[70:71]
    s_nop 1
    v_mfma_f32_16x16x32_bf16 v[56:59], v[24:27], v[16:19], v[80:83]
    v_mfma_f32_16x16x32_bf16 v[64:67], v[28:31], v[20:23], v[72:75]
    v_mfma_f32_16x16x32_bf16 v[60:63], v[32:35], v[16:19], v[76:79]
    v_mfma_f32_16x16x32_bf16 v[68:71], v[36:39], v[20:23], v[76:79]
    s_nop 7
    v_max3_f32 v88, v56, v57, v58
    v_max3_f32 v96, v64, v65, v66
    v_max3_f32 v89, v59, v60, v61
    v_max3_f32 v97, v67, v68, v69
    v_max3_f32 v88, v88, v62, v63
    v_max3_f32 v96, v96, v70, v71
    v_max_f32 v88, v88, v89
    v_max_f32 v96, v96, v97
    v_mov_b32 v89, v88
    v_mov_b32 v97, v96
    s_nop 1
    v_permlane32_swap_b32 v88, v89
    v_permlane32_swap_b32 v96, v97
    v_max_f32 v88, v88, v89
    v_max_f32 v96, v96, v97
    v_mov_b32 v89, v88
    v_mov_b32 v97, v96
    s_nop 1
    v_permlane16_swap_b32 v88, v89
    v_permlane16_swap_b32 v96, v97
    v_max_f32 v88, v88, v89
    v_max_f32 v96, v96, v97
    v_mul_f32 v88, s57, v88
    v_mul_f32 v96, s57, v96
    s_waitcnt lgkmcnt(0)
    s_waitcnt vmcnt(9)
    s_barrier
    s_add_u32 s62, s34, 114688
    s_add_u32 s63, s34, 245760
    s_add_u32 m0, s36, 98304
    s_nop 0
    buffer_load_dwordx4 v8, s[24:27], s62 offen lds
    s_add_u32 m0, s36, 114688
    s_nop 0
    buffer_load_dwordx4 v8, s[24:27], s63 offen lds
    s_add_u32 m0, s36, 102400
    s_nop 0
    buffer_load_dwordx4 v9, s[24:27], s62 offen lds
    s_add_u32 m0, s36, 118784
    s_nop 0
    buffer_load_dwordx4 v9, s[24:27], s63 offen lds
    s_add_u32 m0, s36, 106496
    s_nop 0
    buffer_load_dwordx4 v10, s[24:27], s62 offen lds
    s_add_u32 m0, s36, 122880
    s_nop 0
    buffer_load_dwordx4 v10, s[24:27], s63 offen lds
    s_add_u32 m0, s36, 110592
    s_nop 0
    buffer_load_dwordx4 v11, s[24:27], s62 offen lds
    s_add_u32 m0, s36, 126976
    s_nop 0
    buffer_load_dwordx4 v11, s[24:27], s63 offen lds
    v_fma_f32 v56, v56, s57, -v88
    v_fma_f32 v64, v64, s57, -v96
    v_fma_f32 v57, v57, s57, -v88
    v_fma_f32 v65, v65, s57, -v96
    v_fma_f32 v58, v58, s57, -v88
    v_fma_f32 v66, v66, s57, -v96
    v_fma_f32 v59, v59, s57, -v88
    v_fma_f32 v67, v67, s57, -v96
    v_fma_f32 v60, v60, s57, -v88
    v_fma_f32 v68, v68, s57, -v96
    v_fma_f32 v61, v61, s57, -v88
    v_fma_f32 v69, v69, s57, -v96
    v_fma_f32 v62, v62, s57, -v88
    v_fma_f32 v70, v70, s57, -v96
    v_fma_f32 v63, v63, s57, -v88
    v_fma_f32 v71, v71, s57, -v96
    v_exp_f32 v56, v56
    v_exp_f32 v64, v64
    v_exp_f32 v57, v57
    v_exp_f32 v65, v65
    v_exp_f32 v58, v58
    v_exp_f32 v66, v66
    v_exp_f32 v59, v59
    v_exp_f32 v67, v67
    v_exp_f32 v60, v60
    v_exp_f32 v68, v68
    v_exp_f32 v61, v61
    v_exp_f32 v69, v69
    v_exp_f32 v62, v62
    v_exp_f32 v70, v70
    v_exp_f32 v63, v63
    v_exp_f32 v71, v71
    v_cvt_pk_bf16_f32 v84, v56, v57
    v_cvt_pk_bf16_f32 v92, v64, v65
    v_cvt_pk_bf16_f32 v85, v58, v59
    v_cvt_pk_bf16_f32 v93, v66, v67
    v_cvt_pk_bf16_f32 v86, v60, v61
    v_cvt_pk_bf16_f32 v94, v68, v69
    v_cvt_pk_bf16_f32 v87, v62, v63
    v_cvt_pk_bf16_f32 v95, v70, v71
    s_nop 1
    v_mfma_f32_16x16x32_bf16 v[60:63], v[48:51], v[84:87], 0
    v_mfma_f32_16x16x32_bf16 v[68:71], v[52:55], v[92:95], 0
    v_mfma_f32_16x16x32_bf16 v[56:59], v[40:43], v[84:87], 0
    v_mfma_f32_16x16x32_bf16 v[64:67], v[44:47], v[92:95], 0
    s_waitcnt vmcnt(8)
    s_barrier
    s_nop 7
    v_mov_b32 v88, v60
    v_mov_b32 v96, v68
    v_mov_b32 v89, v60
    v_mov_b32 v97, v68
    s_nop 1
    v_permlane32_swap_b32 v89, v88
    v_permlane32_swap_b32 v97, v96
    v_mov_b32 v89, v88
    v_mov_b32 v97, v96
    s_nop 1
    v_permlane16_swap_b32 v89, v88
    v_permlane16_swap_b32 v97, v96
    v_rcp_f32 v88, v88
    v_rcp_f32 v96, v96
    s_nop 0
    v_mul_f32 v56, v88, v56
    v_mul_f32 v64, v96, v64
    v_mul_f32 v57, v88, v57
    v_mul_f32 v65, v96, v65
    v_mul_f32 v58, v88, v58
    v_mul_f32 v66, v96, v66
    v_mul_f32 v59, v88, v59
    v_mul_f32 v67, v96, v67
    v_mul_f32 v60, v88, v60
    v_mul_f32 v68, v96, v68
    v_mul_f32 v61, v88, v61
    v_mul_f32 v69, v96, v69
    v_mul_f32 v62, v88, v62
    v_mul_f32 v70, v96, v70
    v_mul_f32 v63, v88, v63
    v_mul_f32 v71, v96, v71
    v_cvt_pk_bf16_f32 v84, v56, v57
    v_cvt_pk_bf16_f32 v92, v64, v65
    v_cvt_pk_bf16_f32 v85, v58, v59
    v_cvt_pk_bf16_f32 v93, v66, v67
    v_cvt_pk_bf16_f32 v86, v60, v61
    v_cvt_pk_bf16_f32 v94, v68, v69
    v_cvt_pk_bf16_f32 v87, v62, v63
    v_cvt_pk_bf16_f32 v95, v70, v71
    v_cndmask_b32 v86, v86, v1, s[70:71]
    v_cndmask_b32 v94, v94, v1, s[70:71]
    v_cndmask_b32 v87, v87, v1, s[70:71]
    v_cndmask_b32 v95, v95, v1, s[70:71]
    s_nop 1
    v_permlane32_swap_b32 v84, v86
    v_permlane32_swap_b32 v92, v94
    v_permlane32_swap_b32 v85, v87
    v_permlane32_swap_b32 v93, v95
    buffer_store_dwordx4 v[84:87], v13, s[24:27], s47 offen offset:0 sc1
    buffer_store_dwordx4 v[92:95], v13, s[24:27], s47 offen offset:256 sc1
    ds_write_b32 v7, v1
    s_waitcnt vmcnt(2)
    s_barrier
    s_cmp_eq_u32 s72, 0
    s_cselect_b32 s16, s4, s6
    s_cselect_b32 s17, s5, s7
    s_mov_b32 s18, 401408
    s_mov_b32 s19, 0x00020000
    v_lshrrev_b32 v3, 3, v0
    s_lshl_b32 s41, s28, 3
    v_add_u32 v3, s41, v3
    v_mul_u32_u24 v3, 896, v3
    v_and_b32 v5, 7, v0
    v_bfe_u32 v6, v0, 4, 1
    v_lshlrev_b32 v6, 2, v6
    v_xor_b32 v5, v5, v6
    v_lshl_add_u32 v4, v5, 4, v3
    s_lshl_b32 s41, s73, 7
    v_add_u32 v4, s41, v4
    s_add_u32 m0, s36, 131072
    s_mov_b32 s50, 0
    buffer_load_dwordx4 v4, s[16:19], s50 offen lds
    s_add_u32 m0, s36, 135168
    s_mov_b32 s50, 28672
    buffer_load_dwordx4 v4, s[16:19], s50 offen lds
    s_add_u32 m0, s36, 139264
    s_mov_b32 s50, 57344
    buffer_load_dwordx4 v4, s[16:19], s50 offen lds
    s_add_u32 m0, s36, 143360
    s_mov_b32 s50, 86016
    buffer_load_dwordx4 v4, s[16:19], s50 offen lds
    s_add_u32 m0, s36, 147456
    s_mov_b32 s50, 114688
    buffer_load_dwordx4 v4, s[16:19], s50 offen lds
    s_add_u32 m0, s36, 151552
    s_mov_b32 s50, 143360
    buffer_load_dwordx4 v4, s[16:19], s50 offen lds
    s_add_u32 m0, s36, 155648
    s_mov_b32 s50, 172032
    buffer_load_dwordx4 v4, s[16:19], s50 offen lds
    s_add_u32 m0, s36, 32768
    s_mov_b32 s50, 200704
    buffer_load_dwordx4 v4, s[16:19], s50 offen lds
    s_add_u32 m0, s36, 36864
    s_mov_b32 s50, 229376
    buffer_load_dwordx4 v4, s[16:19], s50 offen lds
    s_add_u32 m0, s36, 40960
    s_mov_b32 s50, 258048
    buffer_load_dwordx4 v4, s[16:19], s50 offen lds
    s_add_u32 m0, s36, 45056
    s_mov_b32 s50, 286720
    buffer_load_dwordx4 v4, s[16:19], s50 offen lds
    s_add_u32 m0, s36, 49152
    s_mov_b32 s50, 315392
    buffer_load_dwordx4 v4, s[16:19], s50 offen lds
    s_add_u32 m0, s36, 53248
    s_mov_b32 s50, 344064
    buffer_load_dwordx4 v4, s[16:19], s50 offen lds
    s_add_u32 m0, s36, 57344
    s_mov_b32 s50, 372736
    buffer_load_dwordx4 v4, s[16:19], s50 offen lds
    s_waitcnt vmcnt(14) lgkmcnt(0)
    s_barrier
    s_barrier
    ds_read_b32 v5, v7
    s_waitcnt lgkmcnt(0)
    v_readfirstlane_b32 s41, v5
    s_nop 3
    s_cmp_lg_u32 s41, 0
    s_cbranch_scc1 L_k2_auxfb
    s_cmp_lg_u32 s28, 0
    s_cbranch_scc1 L_k2_go
    s_mul_i32 s41, s31, 8320
    s_add_u32 s41, s41, 16777216
    s_mov_b64 exec, 1
    v_mov_b32 v3, 1
    buffer_atomic_add v3, v1, s[24:27], s41 offen sc1
    s_cmp_ge_u32 s75, 14
    s_cbranch_scc1 L_k2_end
    s_mov_b32 s42, 0
    s_mul_i32 s41, s74, 8320
    s_add_u32 s41, s41, 16777216
L_k2_poll:
    s_sleep 8
    buffer_load_dword v5, v1, s[24:27], s41 offen sc1
    s_add_u32 s42, s42, 1
    s_waitcnt vmcnt(0)
    v_readfirstlane_b32 s43, v5
    s_nop 3
    s_cmp_ge_u32 s43, 16
    s_cbranch_scc1 L_k2_go
    s_cmp_lt_u32 s42, 0x40000
    s_cbranch_scc1 L_k2_poll
L_k2_go:
    s_cmp_ge_u32 s75, 14
    s_cbranch_scc1 L_k2_end
    s_waitcnt vmcnt(0)
    s_barrier
    s_endpgm
L_k2_auxfb:
    s_waitcnt vmcnt(0)
    s_barrier
    s_branch L_k2_aux2
L_k2_proj:
    s_cmp_ge_u32 s28, 4
    s_cbranch_scc1 L_k2_end
    s_cmp_ge_u32 s75, 14
    s_cbranch_scc1 L_k2_end
    s_lshl_b32 s34, s74, 2
    s_add_u32 s34, s34, s28
    s_lshl_b32 s34, s34, 15
    s_lshl_b32 s35, s72, 21
    s_add_u32 s34, s34, s35
    s_add_u32 s34, s34, 12582912
    s_mov_b32 s20, s8
    s_mov_b32 s21, s9
    s_mov_b32 s22, 3670016
    s_mov_b32 s23, 0x00020000
    v_lshrrev_b32 v145, 5, v0
    v_bfe_u32 v146, v0, 2, 2
    v_lshl_add_u32 v147, v145, 2, v146
    v_lshlrev_b32 v147, 7, v147
    v_bfe_u32 v148, v0, 4, 1
    v_lshl_add_u32 v147, v148, 5, v147
    v_and_b32 v148, 3, v0
    v_lshl_add_u32 v147, v148, 3, v147
    v_lshrrev_b32 v146, 1, v146
    v_lshl_add_u32 v147, v146, 6, v147
    v_add_u32 v3, 131072, v147
    v_xor_b32 v4, 64, v3
    v_lshlrev_b32 v148, 10, v145
    v_sub_u32 v5, v3, v148
    v_sub_u32 v6, v4, v148
    v_subrev_u32 v8, 98304, v3
    v_subrev_u32 v9, 98304, v4
    v_subrev_u32 v10, 98304, v5
    v_subrev_u32 v11, 98304, v6
    s_mul_i32 s37, s28, 4608
    s_add_u32 s37, s37, 65536
    v_and_b32 v146, 31, v0
    v_mul_u32_u24 v12, 144, v146
    v_lshl_add_u32 v12, v145, 3, v12
    v_add_u32 v12, s37, v12
    v_lshrrev_b32 v146, 3, v0
    v_and_b32 v147, 7, v0
    v_mul_u32_u24 v13, 144, v146
    v_lshl_add_u32 v13, v147, 4, v13
    v_add_u32 v13, s37, v13
    v_mul_u32_u24 v14, 1792, v146
    v_lshl_add_u32 v14, v147, 4, v14
    s_lshl_b32 s39, s74, 7
    s_lshl_b32 s40, s28, 5
    s_add_u32 s39, s39, s40
    s_mul_i32 s39, s39, 1792
    s_mul_i32 s40, s72, 896
    s_add_u32 s39, s39, s40
    s_lshl_b32 s40, s73, 7
    s_add_u32 s39, s39, s40
    s_barrier
    s_add_u32 s36, s34, 0
    buffer_load_dwordx4 v[16:19], v2, s[24:27], s36 offen offset:0 sc1
    buffer_load_dwordx4 v[20:23], v2, s[24:27], s36 offen offset:1024 sc1
    buffer_load_dwordx4 v[24:27], v2, s[24:27], s36 offen offset:2048 sc1
    buffer_load_dwordx4 v[28:31], v2, s[24:27], s36 offen offset:3072 sc1
    s_add_u32 s36, s34, 4096
    buffer_load_dwordx4 v[32:35], v2, s[24:27], s36 offen offset:0 sc1
    buffer_load_dwordx4 v[36:39], v2, s[24:27], s36 offen offset:1024 sc1
    buffer_load_dwordx4 v[40:43], v2, s[24:27], s36 offen offset:2048 sc1
    buffer_load_dwordx4 v[44:47], v2, s[24:27], s36 offen offset:3072 sc1
    s_add_u32 s36, s34, 8192
    buffer_load_dwordx4 v[48:51], v2, s[24:27], s36 offen offset:0 sc1
    buffer_load_dwordx4 v[52:55], v2, s[24:27], s36 offen offset:1024 sc1
    buffer_load_dwordx4 v[56:59], v2, s[24:27], s36 offen offset:2048 sc1
    buffer_load_dwordx4 v[60:63], v2, s[24:27], s36 offen offset:3072 sc1
    s_add_u32 s36, s34, 12288
    buffer_load_dwordx4 v[64:67], v2, s[24:27], s36 offen offset:0 sc1
    buffer_load_dwordx4 v[68:71], v2, s[24:27], s36 offen offset:1024 sc1
    buffer_load_dwordx4 v[72:75], v2, s[24:27], s36 offen offset:2048 sc1
    buffer_load_dwordx4 v[76:79], v2, s[24:27], s36 offen offset:3072 sc1
    ds_read_b64_tr_b16 v[80:81], v3 offset:0
    ds_read_b64_tr_b16 v[82:83], v3 offset:1024
    ds_read_b64_tr_b16 v[84:85], v3 offset:2048
    ds_read_b64_tr_b16 v[86:87], v5 offset:3072
    ds_read_b64_tr_b16 v[88:89], v4 offset:0
    ds_read_b64_tr_b16 v[90:91], v4 offset:1024
    ds_read_b64_tr_b16 v[92:93], v4 offset:2048
    ds_read_b64_tr_b16 v[94:95], v6 offset:3072
    s_waitcnt vmcnt(14) lgkmcnt(0)
    v_mfma_f32_32x32x16_bf16 v[112:127], v[80:83], v[16:19], 0
    ds_read_b64_tr_b16 v[96:97], v3 offset:3584
    ds_read_b64_tr_b16 v[98:99], v3 offset:4608
    v_mfma_f32_32x32x16_bf16 v[128:143], v[88:91], v[16:19], 0
    ds_read_b64_tr_b16 v[100:101], v3 offset:5632
    ds_read_b64_tr_b16 v[102:103], v5 offset:6656
    v_mfma_f32_32x32x16_bf16 v[112:127], v[84:87], v[20:23], v[112:127]
    ds_read_b64_tr_b16 v[104:105], v4 offset:3584
    ds_read_b64_tr_b16 v[106:107], v4 offset:4608
    v_mfma_f32_32x32x16_bf16 v[128:143], v[92:95], v[20:23], v[128:143]
    ds_read_b64_tr_b16 v[108:109], v4 offset:5632
    ds_read_b64_tr_b16 v[110:111], v6 offset:6656
    s_add_u32 s36, s34, 16384
    buffer_load_dwordx4 v[16:19], v2, s[24:27], s36 offen offset:0 sc1
    buffer_load_dwordx4 v[20:23], v2, s[24:27], s36 offen offset:1024 sc1
    s_waitcnt vmcnt(14) lgkmcnt(0)
    v_mfma_f32_32x32x16_bf16 v[112:127], v[96:99], v[24:27], v[112:127]
    ds_read_b64_tr_b16 v[80:81], v3 offset:7168
    ds_read_b64_tr_b16 v[82:83], v3 offset:8192
    v_mfma_f32_32x32x16_bf16 v[128:143], v[104:107], v[24:27], v[128:143]
    ds_read_b64_tr_b16 v[84:85], v3 offset:9216
    ds_read_b64_tr_b16 v[86:87], v5 offset:10240
    v_mfma_f32_32x32x16_bf16 v[112:127], v[100:103], v[28:31], v[112:127]
    ds_read_b64_tr_b16 v[88:89], v4 offset:7168
    ds_read_b64_tr_b16 v[90:91], v4 offset:8192
    v_mfma_f32_32x32x16_bf16 v[128:143], v[108:111], v[28:31], v[128:143]
    ds_read_b64_tr_b16 v[92:93], v4 offset:9216
    ds_read_b64_tr_b16 v[94:95], v6 offset:10240
    buffer_load_dwordx4 v[24:27], v2, s[24:27], s36 offen offset:2048 sc1
    buffer_load_dwordx4 v[28:31], v2, s[24:27], s36 offen offset:3072 sc1
    s_waitcnt vmcnt(14) lgkmcnt(0)
    v_mfma_f32_32x32x16_bf16 v[112:127], v[80:83], v[32:35], v[112:127]
    ds_read_b64_tr_b16 v[96:97], v3 offset:10752
    ds_read_b64_tr_b16 v[98:99], v3 offset:11776
    v_mfma_f32_32x32x16_bf16 v[128:143], v[88:91], v[32:35], v[128:143]
    ds_read_b64_tr_b16 v[100:101], v3 offset:12800
    ds_read_b64_tr_b16 v[102:103], v5 offset:13824
    v_mfma_f32_32x32x16_bf16 v[112:127], v[84:87], v[36:39], v[112:127]
    ds_read_b64_tr_b16 v[104:105], v4 offset:10752
    ds_read_b64_tr_b16 v[106:107], v4 offset:11776
    v_mfma_f32_32x32x16_bf16 v[128:143], v[92:95], v[36:39], v[128:143]
    ds_read_b64_tr_b16 v[108:109], v4 offset:12800
    ds_read_b64_tr_b16 v[110:111], v6 offset:13824
    s_add_u32 s36, s34, 20480
    buffer_load_dwordx4 v[32:35], v2, s[24:27], s36 offen offset:0 sc1
    buffer_load_dwordx4 v[36:39], v2, s[24:27], s36 offen offset:1024 sc1
    s_waitcnt vmcnt(14) lgkmcnt(0)
    v_mfma_f32_32x32x16_bf16 v[112:127], v[96:99], v[40:43], v[112:127]
    ds_read_b64_tr_b16 v[80:81], v3 offset:14336
    ds_read_b64_tr_b16 v[82:83], v3 offset:15360
    v_mfma_f32_32x32x16_bf16 v[128:143], v[104:107], v[40:43], v[128:143]
    ds_read_b64_tr_b16 v[84:85], v3 offset:16384
    ds_read_b64_tr_b16 v[86:87], v5 offset:17408
    v_mfma_f32_32x32x16_bf16 v[112:127], v[100:103], v[44:47], v[112:127]
    ds_read_b64_tr_b16 v[88:89], v4 offset:14336
    ds_read_b64_tr_b16 v[90:91], v4 offset:15360
    v_mfma_f32_32x32x16_bf16 v[128:143], v[108:111], v[44:47], v[128:143]
    ds_read_b64_tr_b16 v[92:93], v4 offset:16384
    ds_read_b64_tr_b16 v[94:95], v6 offset:17408
    buffer_load_dwordx4 v[40:43], v2, s[24:27], s36 offen offset:2048 sc1
    buffer_load_dwordx4 v[44:47], v2, s[24:27], s36 offen offset:3072 sc1
    s_waitcnt vmcnt(14) lgkmcnt(0)
    v_mfma_f32_32x32x16_bf16 v[112:127], v[80:83], v[48:51], v[112:127]
    ds_read_b64_tr_b16 v[96:97], v3 offset:17920
    ds_read_b64_tr_b16 v[98:99], v3 offset:18944
    v_mfma_f32_32x32x16_bf16 v[128:143], v[88:91], v[48:51], v[128:143]
    ds_read_b64_tr_b16 v[100:101], v3 offset:19968
    ds_read_b64_tr_b16 v[102:103], v5 offset:20992
    v_mfma_f32_32x32x16_bf16 v[112:127], v[84:87], v[52:55], v[112:127]
    ds_read_b64_tr_b16 v[104:105], v4 offset:17920
    ds_read_b64_tr_b16 v[106:107], v4 offset:18944
    v_mfma_f32_32x32x16_bf16 v[128:143], v[92:95], v[52:55], v[128:143]
    ds_read_b64_tr_b16 v[108:109], v4 offset:19968
    ds_read_b64_tr_b16 v[110:111], v6 offset:20992
    s_add_u32 s36, s34, 24576
    buffer_load_dwordx4 v[48:51], v2, s[24:27], s36 offen offset:0 sc1
    buffer_load_dwordx4 v[52:55], v2, s[24:27], s36 offen offset:1024 sc1
    s_waitcnt vmcnt(14) lgkmcnt(0)
    v_mfma_f32_32x32x16_bf16 v[112:127], v[96:99], v[56:59], v[112:127]
    ds_read_b64_tr_b16 v[80:81], v3 offset:21504
    ds_read_b64_tr_b16 v[82:83], v3 offset:22528
    v_mfma_f32_32x32x16_bf16 v[128:143], v[104:107], v[56:59], v[128:143]
    ds_read_b64_tr_b16 v[84:85], v3 offset:23552
    ds_read_b64_tr_b16 v[86:87], v5 offset:24576
    v_mfma_f32_32x32x16_bf16 v[112:127], v[100:103], v[60:63], v[112:127]
    ds_read_b64_tr_b16 v[88:89], v4 offset:21504
    ds_read_b64_tr_b16 v[90:91], v4 offset:22528
    v_mfma_f32_32x32x16_bf16 v[128:143], v[108:111], v[60:63], v[128:143]
    ds_read_b64_tr_b16 v[92:93], v4 offset:23552
    ds_read_b64_tr_b16 v[94:95], v6 offset:24576
    buffer_load_dwordx4 v[56:59], v2, s[24:27], s36 offen offset:2048 sc1
    buffer_load_dwordx4 v[60:63], v2, s[24:27], s36 offen offset:3072 sc1
    s_waitcnt vmcnt(14) lgkmcnt(0)
    v_mfma_f32_32x32x16_bf16 v[112:127], v[80:83], v[64:67], v[112:127]
    ds_read_b64_tr_b16 v[96:97], v3 offset:25088
    ds_read_b64_tr_b16 v[98:99], v3 offset:26112
    v_mfma_f32_32x32x16_bf16 v[128:143], v[88:91], v[64:67], v[128:143]
    ds_read_b64_tr_b16 v[100:101], v3 offset:27136
    ds_read_b64_tr_b16 v[102:103], v5 offset:28160
    v_mfma_f32_32x32x16_bf16 v[112:127], v[84:87], v[68:71], v[112:127]
    ds_read_b64_tr_b16 v[104:105], v4 offset:25088
    ds_read_b64_tr_b16 v[106:107], v4 offset:26112
    v_mfma_f32_32x32x16_bf16 v[128:143], v[92:95], v[68:71], v[128:143]
    ds_read_b64_tr_b16 v[108:109], v4 offset:27136
    ds_read_b64_tr_b16 v[110:111], v6 offset:28160
    s_add_u32 s36, s34, 28672
    buffer_load_dwordx4 v[64:67], v2, s[24:27], s36 offen offset:0 sc1
    buffer_load_dwordx4 v[68:71], v2, s[24:27], s36 offen offset:1024 sc1
    s_waitcnt vmcnt(14) lgkmcnt(0)
    v_mfma_f32_32x32x16_bf16 v[112:127], v[96:99], v[72:75], v[112:127]
    ds_read_b64_tr_b16 v[80:81], v8 offset:0
    ds_read_b64_tr_b16 v[82:83], v8 offset:1024
    v_mfma_f32_32x32x16_bf16 v[128:143], v[104:107], v[72:75], v[128:143]
    ds_read_b64_tr_b16 v[84:85], v8 offset:2048
    ds_read_b64_tr_b16 v[86:87], v10 offset:3072
    v_mfma_f32_32x32x16_bf16 v[112:127], v[100:103], v[76:79], v[112:127]
    ds_read_b64_tr_b16 v[88:89], v9 offset:0
    ds_read_b64_tr_b16 v[90:91], v9 offset:1024
    v_mfma_f32_32x32x16_bf16 v[128:143], v[108:111], v[76:79], v[128:143]
    ds_read_b64_tr_b16 v[92:93], v9 offset:2048
    ds_read_b64_tr_b16 v[94:95], v11 offset:3072
    buffer_load_dwordx4 v[72:75], v2, s[24:27], s36 offen offset:2048 sc1
    buffer_load_dwordx4 v[76:79], v2, s[24:27], s36 offen offset:3072 sc1
    s_waitcnt vmcnt(14) lgkmcnt(0)
    v_mfma_f32_32x32x16_bf16 v[112:127], v[80:83], v[16:19], v[112:127]
    ds_read_b64_tr_b16 v[96:97], v8 offset:3584
    ds_read_b64_tr_b16 v[98:99], v8 offset:4608
    v_mfma_f32_32x32x16_bf16 v[128:143], v[88:91], v[16:19], v[128:143]
    ds_read_b64_tr_b16 v[100:101], v8 offset:5632
    ds_read_b64_tr_b16 v[102:103], v10 offset:6656
    v_mfma_f32_32x32x16_bf16 v[112:127], v[84:87], v[20:23], v[112:127]
    ds_read_b64_tr_b16 v[104:105], v9 offset:3584
    ds_read_b64_tr_b16 v[106:107], v9 offset:4608
    v_mfma_f32_32x32x16_bf16 v[128:143], v[92:95], v[20:23], v[128:143]
    ds_read_b64_tr_b16 v[108:109], v9 offset:5632
    ds_read_b64_tr_b16 v[110:111], v11 offset:6656
    s_waitcnt vmcnt(12) lgkmcnt(0)
    v_mfma_f32_32x32x16_bf16 v[112:127], v[96:99], v[24:27], v[112:127]
    ds_read_b64_tr_b16 v[80:81], v8 offset:7168
    ds_read_b64_tr_b16 v[82:83], v8 offset:8192
    v_mfma_f32_32x32x16_bf16 v[128:143], v[104:107], v[24:27], v[128:143]
    ds_read_b64_tr_b16 v[84:85], v8 offset:9216
    ds_read_b64_tr_b16 v[86:87], v10 offset:10240
    v_mfma_f32_32x32x16_bf16 v[112:127], v[100:103], v[28:31], v[112:127]
    ds_read_b64_tr_b16 v[88:89], v9 offset:7168
    ds_read_b64_tr_b16 v[90:91], v9 offset:8192
    v_mfma_f32_32x32x16_bf16 v[128:143], v[108:111], v[28:31], v[128:143]
    ds_read_b64_tr_b16 v[92:93], v9 offset:9216
    ds_read_b64_tr_b16 v[94:95], v11 offset:10240
    s_waitcnt vmcnt(10) lgkmcnt(0)
    v_mfma_f32_32x32x16_bf16 v[112:127], v[80:83], v[32:35], v[112:127]
    ds_read_b64_tr_b16 v[96:97], v8 offset:10752
    ds_read_b64_tr_b16 v[98:99], v8 offset:11776
    v_mfma_f32_32x32x16_bf16 v[128:143], v[88:91], v[32:35], v[128:143]
    ds_read_b64_tr_b16 v[100:101], v8 offset:12800
    ds_read_b64_tr_b16 v[102:103], v10 offset:13824
    v_mfma_f32_32x32x16_bf16 v[112:127], v[84:87], v[36:39], v[112:127]
    ds_read_b64_tr_b16 v[104:105], v9 offset:10752
    ds_read_b64_tr_b16 v[106:107], v9 offset:11776
    v_mfma_f32_32x32x16_bf16 v[128:143], v[92:95], v[36:39], v[128:143]
    ds_read_b64_tr_b16 v[108:109], v9 offset:12800
    ds_read_b64_tr_b16 v[110:111], v11 offset:13824
    s_waitcnt vmcnt(8) lgkmcnt(0)
    v_mfma_f32_32x32x16_bf16 v[112:127], v[96:99], v[40:43], v[112:127]
    ds_read_b64_tr_b16 v[80:81], v8 offset:14336
    ds_read_b64_tr_b16 v[82:83], v8 offset:15360
    v_mfma_f32_32x32x16_bf16 v[128:143], v[104:107], v[40:43], v[128:143]
    ds_read_b64_tr_b16 v[84:85], v8 offset:16384
    ds_read_b64_tr_b16 v[86:87], v10 offset:17408
    v_mfma_f32_32x32x16_bf16 v[112:127], v[100:103], v[44:47], v[112:127]
    ds_read_b64_tr_b16 v[88:89], v9 offset:14336
    ds_read_b64_tr_b16 v[90:91], v9 offset:15360
    v_mfma_f32_32x32x16_bf16 v[128:143], v[108:111], v[44:47], v[128:143]
    ds_read_b64_tr_b16 v[92:93], v9 offset:16384
    ds_read_b64_tr_b16 v[94:95], v11 offset:17408
    s_waitcnt vmcnt(6) lgkmcnt(0)
    v_mfma_f32_32x32x16_bf16 v[112:127], v[80:83], v[48:51], v[112:127]
    ds_read_b64_tr_b16 v[96:97], v8 offset:17920
    ds_read_b64_tr_b16 v[98:99], v8 offset:18944
    v_mfma_f32_32x32x16_bf16 v[128:143], v[88:91], v[48:51], v[128:143]
    ds_read_b64_tr_b16 v[100:101], v8 offset:19968
    ds_read_b64_tr_b16 v[102:103], v10 offset:20992
    v_mfma_f32_32x32x16_bf16 v[112:127], v[84:87], v[52:55], v[112:127]
    ds_read_b64_tr_b16 v[104:105], v9 offset:17920
    ds_read_b64_tr_b16 v[106:107], v9 offset:18944
    v_mfma_f32_32x32x16_bf16 v[128:143], v[92:95], v[52:55], v[128:143]
    ds_read_b64_tr_b16 v[108:109], v9 offset:19968
    ds_read_b64_tr_b16 v[110:111], v11 offset:20992
    s_waitcnt vmcnt(4) lgkmcnt(0)
    v_mfma_f32_32x32x16_bf16 v[112:127], v[96:99], v[56:59], v[112:127]
    ds_read_b64_tr_b16 v[80:81], v8 offset:21504
    ds_read_b64_tr_b16 v[82:83], v8 offset:22528
    v_mfma_f32_32x32x16_bf16 v[128:143], v[104:107], v[56:59], v[128:143]
    ds_read_b64_tr_b16 v[84:85], v8 offset:23552
    ds_read_b64_tr_b16 v[86:87], v10 offset:24576
    v_mfma_f32_32x32x16_bf16 v[112:127], v[100:103], v[60:63], v[112:127]
    ds_read_b64_tr_b16 v[88:89], v9 offset:21504
    ds_read_b64_tr_b16 v[90:91], v9 offset:22528
    v_mfma_f32_32x32x16_bf16 v[128:143], v[108:111], v[60:63], v[128:143]
    ds_read_b64_tr_b16 v[92:93], v9 offset:23552
    ds_read_b64_tr_b16 v[94:95], v11 offset:24576
    s_waitcnt vmcnt(2) lgkmcnt(0)
    v_mfma_f32_32x32x16_bf16 v[112:127], v[80:83], v[64:67], v[112:127]
    ds_read_b64_tr_b16 v[96:97], v8 offset:25088
    ds_read_b64_tr_b16 v[98:99], v8 offset:26112
    v_mfma_f32_32x32x16_bf16 v[128:143], v[88:91], v[64:67], v[128:143]
    ds_read_b64_tr_b16 v[100:101], v8 offset:27136
    ds_read_b64_tr_b16 v[102:103], v10 offset:28160
    v_mfma_f32_32x32x16_bf16 v[112:127], v[84:87], v[68:71], v[112:127]
    ds_read_b64_tr_b16 v[104:105], v9 offset:25088
    ds_read_b64_tr_b16 v[106:107], v9 offset:26112
    v_mfma_f32_32x32x16_bf16 v[128:143], v[92:95], v[68:71], v[128:143]
    ds_read_b64_tr_b16 v[108:109], v9 offset:27136
    ds_read_b64_tr_b16 v[110:111], v11 offset:28160
    s_waitcnt vmcnt(0) lgkmcnt(0)
    v_mfma_f32_32x32x16_bf16 v[112:127], v[96:99], v[72:75], v[112:127]
    v_mfma_f32_32x32x16_bf16 v[128:143], v[104:107], v[72:75], v[128:143]
    v_mfma_f32_32x32x16_bf16 v[112:127], v[100:103], v[76:79], v[112:127]
    v_mfma_f32_32x32x16_bf16 v[128:143], v[108:111], v[76:79], v[128:143]
    s_nop 7
    s_nop 3
    v_cvt_pk_bf16_f32 v16, v112, v113
    v_cvt_pk_bf16_f32 v17, v114, v115
    ds_write_b64 v12, v[16:17] offset:0
    v_cvt_pk_bf16_f32 v18, v116, v117
    v_cvt_pk_bf16_f32 v19, v118, v119
    ds_write_b64 v12, v[18:19] offset:16
    v_cvt_pk_bf16_f32 v20, v120, v121
    v_cvt_pk_bf16_f32 v21, v122, v123
    ds_write_b64 v12, v[20:21] offset:32
    v_cvt_pk_bf16_f32 v22, v124, v125
    v_cvt_pk_bf16_f32 v23, v126, v127
    ds_write_b64 v12, v[22:23] offset:48
    v_cvt_pk_bf16_f32 v24, v128, v129
    v_cvt_pk_bf16_f32 v25, v130, v131
    ds_write_b64 v12, v[24:25] offset:64
    v_cvt_pk_bf16_f32 v26, v132, v133
    v_cvt_pk_bf16_f32 v27, v134, v135
    ds_write_b64 v12, v[26:27] offset:80
    v_cvt_pk_bf16_f32 v28, v136, v137
    v_cvt_pk_bf16_f32 v29, v138, v139
    ds_write_b64 v12, v[28:29] offset:96
    v_cvt_pk_bf16_f32 v30, v140, v141
    v_cvt_pk_bf16_f32 v31, v142, v143
    ds_write_b64 v12, v[30:31] offset:112
    s_waitcnt lgkmcnt(0)
    ds_read_b128 v[32:35], v13 offset:0
    ds_read_b128 v[36:39], v13 offset:1152
    ds_read_b128 v[40:43], v13 offset:2304
    ds_read_b128 v[44:47], v13 offset:3456
    s_add_u32 s40, s39, 0
    s_waitcnt lgkmcnt(3)
    buffer_store_dwordx4 v[32:35], v14, s[20:23], s40 offen sc1
    s_add_u32 s40, s39, 14336
    s_waitcnt lgkmcnt(2)
    buffer_store_dwordx4 v[36:39], v14, s[20:23], s40 offen sc1
    s_add_u32 s40, s39, 28672
    s_waitcnt lgkmcnt(1)
    buffer_store_dwordx4 v[40:43], v14, s[20:23], s40 offen sc1
    s_add_u32 s40, s39, 43008
    s_waitcnt lgkmcnt(0)
    buffer_store_dwordx4 v[44:47], v14, s[20:23], s40 offen sc1
L_k2_end:
    s_endpgm
.section .rodata,"a"
.p2align 6
.amdhsa_kernel qkv_kernel
  .amdhsa_next_free_vgpr 256
  .amdhsa_next_free_sgpr 80
  .amdhsa_accum_offset 256
  .amdhsa_group_segment_fixed_size 0
  .amdhsa_kernarg_size 72
  .amdhsa_user_sgpr_count 2
  .amdhsa_user_sgpr_kernarg_segment_ptr 1
  .amdhsa_system_sgpr_workgroup_id_x 1
.end_amdhsa_kernel
.p2align 6
.amdhsa_kernel attn_kernel
  .amdhsa_next_free_vgpr 152
  .amdhsa_next_free_sgpr 80
  .amdhsa_accum_offset 152
  .amdhsa_group_segment_fixed_size 0
  .amdhsa_kernarg_size 72
  .amdhsa_user_sgpr_count 2
  .amdhsa_user_sgpr_kernarg_segment_ptr 1
  .amdhsa_system_sgpr_workgroup_id_x 1
.end_amdhsa_kernel
```
